```python
import torch

def _softmax(x, axis=-1):
    return torch.softmax(x, dim=axis)
def _gelu(x):
    return torch.nn.functional.gelu(x, approximate="tanh")
def _silu(x):
    return torch.nn.functional.silu(x)
def _sigmoid(x):
    return torch.sigmoid(x)
def _layernorm(x, axis=-1, eps=1e-5):
    m = x.mean(dim=axis, keepdim=True)
    v = x.var(dim=axis, keepdim=True, unbiased=False)
    return (x - m) / torch.sqrt(v + eps)
def _scatter_add(tgt, idx, src, axis=0):
    return tgt.clone().index_add_(axis, idx, src)
def _segment_sum(src, seg, n):
    out = torch.zeros((n,) + src.shape[1:], dtype=src.dtype)
    return out.index_add_(0, seg, src)
def _pad(x, pw):
    flat = tuple(v for pair in reversed(pw) for v in pair)
    return torch.nn.functional.pad(x, flat)

kernel_name = 'concat_heads__gqa_block_cached__gqa_block_cached__near_ridge'

def setup_inputs():

    _w = (lambda a: (lambda t: t.to(torch.bfloat16) if t.is_floating_point() else t)(torch.as_tensor(a)))
    def _A_setup():
        B, Sq, D = 16, 80, 512
        Hq, Hkv, Sk, Dh = 32, 32, 80, 128
        assert Hq % Hkv == 0, (Hq, Hkv)
        return {
            "x": _w((lambda *s: torch.randn(*s, dtype=torch.bfloat16) * 0.8)(B, Sq, D)),
            "k_cache": _w((lambda *s: torch.randn(*s, dtype=torch.bfloat16) * 0.8)(B, Hkv, Sk, Dh)),
            "v_cache": _w((lambda *s: torch.randn(*s, dtype=torch.bfloat16) * 0.05)(B, Hkv, Sk, Dh)),
            "wq": _w((lambda *s: torch.randn(*s, dtype=torch.bfloat16) * 0.8)(D, Hq * Dh) * (D ** -0.5)),
            "wo": _w((lambda *s: torch.randn(*s, dtype=torch.bfloat16) * 0.05)(Hq * Dh, D) * ((Hq * Dh) ** -0.5)),
        }
    _A_in = _A_setup()

    def _B_setup():
        B, Sq, D = 16, 80, 512
        Hq, Hkv, Sk, Dh = 32, 32, 80, 128
        assert Hq % Hkv == 0, (Hq, Hkv)
        return {
            "x": _w((lambda *s: torch.randn(*s, dtype=torch.bfloat16) * 0.8)(B, Sq, D)),
            "k_cache": _w((lambda *s: torch.randn(*s, dtype=torch.bfloat16) * 0.8)(B, Hkv, Sk, Dh)),
            "v_cache": _w((lambda *s: torch.randn(*s, dtype=torch.bfloat16) * 0.05)(B, Hkv, Sk, Dh)),
            "wq": _w((lambda *s: torch.randn(*s, dtype=torch.bfloat16) * 0.8)(D, Hq * Dh) * (D ** -0.5)),
            "wo": _w((lambda *s: torch.randn(*s, dtype=torch.bfloat16) * 0.05)(Hq * Dh, D) * ((Hq * Dh) ** -0.5)),
        }
    _B_in = _B_setup()

    return {
        "A_x": _A_in["x"],
        "A_k_cache": _A_in["k_cache"],
        "A_v_cache": _A_in["v_cache"],
        "A_wq": _A_in["wq"],
        "A_wo": _A_in["wo"],
        "B_x": _B_in["x"],
        "B_k_cache": _B_in["k_cache"],
        "B_v_cache": _B_in["v_cache"],
        "B_wq": _B_in["wq"],
        "B_wo": _B_in["wo"],
    }

def reference(A_x, A_k_cache, A_v_cache, A_wq, A_wo, B_x, B_k_cache, B_v_cache, B_wq, B_wo):
    def _A_ref(x, k_cache, v_cache, wq, wo):
        B, Sq, D = x.shape
        Hq, Dh = 32, 128
        Hkv = k_cache.shape[1]
        rep = Hq // Hkv
        q = (lambda x, *d: x.permute(*d))((x @ wq).reshape(B, Sq, Hq, Dh), 0, 2, 1, 3)
        k = (lambda x, n, axis: torch.repeat_interleave(x, n, dim=axis))(k_cache, rep, axis=1)
        v = (lambda x, n, axis: torch.repeat_interleave(x, n, dim=axis))(v_cache, rep, axis=1)
        scores = torch.einsum("bhqd,bhkd->bhqk", q, k) * (Dh ** -0.5)
        p = _softmax(scores, axis=-1)
        o = torch.einsum("bhqk,bhkd->bhqd", p, v)
        return (lambda x, *d: x.permute(*d))(o, 0, 2, 1, 3).reshape(B, Sq, Hq * Dh) @ wo

    def _B_ref(x, k_cache, v_cache, wq, wo):
        B, Sq, D = x.shape
        Hq, Dh = 32, 128
        Hkv = k_cache.shape[1]
        rep = Hq // Hkv
        q = (lambda x, *d: x.permute(*d))((x @ wq).reshape(B, Sq, Hq, Dh), 0, 2, 1, 3)
        k = (lambda x, n, axis: torch.repeat_interleave(x, n, dim=axis))(k_cache, rep, axis=1)
        v = (lambda x, n, axis: torch.repeat_interleave(x, n, dim=axis))(v_cache, rep, axis=1)
        scores = torch.einsum("bhqd,bhkd->bhqk", q, k) * (Dh ** -0.5)
        p = _softmax(scores, axis=-1)
        o = torch.einsum("bhqk,bhkd->bhqd", p, v)
        return (lambda x, *d: x.permute(*d))(o, 0, 2, 1, 3).reshape(B, Sq, Hq * Dh) @ wo

    a = _A_ref(A_x, A_k_cache, A_v_cache, A_wq, A_wo)
    b = _B_ref(B_x, B_k_cache, B_v_cache, B_wq, B_wo)
    return torch.concatenate([a, b], axis=-1)
```

```asm
; @launch grid=(256,1,1) block=(256,1,1) lds=163840
.amdgcn_target "amdgcn-amd-amdhsa--gfx950"
.text
.globl concat_heads__gqa_block_cached__gqa_block_cached__near_ridge_kernel
.p2align 8
.type concat_heads__gqa_block_cached__gqa_block_cached__near_ridge_kernel,@function
concat_heads__gqa_block_cached__gqa_block_cached__near_ridge_kernel:
    s_cmp_ge_u32 s2, 256
    s_cbranch_scc1 L_end
    s_nop 0
    s_load_dwordx16 s[64:79], s[0:1], 0
    s_load_dwordx8 s[80:87], s[0:1], 64
    s_load_dwordx2 s[88:89], s[0:1], 96
    s_getpc_b64 s[90:91]
    v_lshlrev_b32 v8, 7, v0
    v_mov_b32 v9, s91
    v_add_co_u32 v8, vcc, s90, v8
    s_nop 1
    v_addc_co_u32 v9, vcc, 0, v9, vcc
    global_load_dword v112, v[8:9], off
    v_add_co_u32 v8, vcc, 0x8000, v8
    s_nop 1
    v_addc_co_u32 v9, vcc, 0, v9, vcc
    v_cmp_gt_u32 vcc, 128, v0
    s_nop 1
    s_and_saveexec_b64 s[92:93], vcc
    s_cbranch_execz L_pf
    s_nop 0
    global_load_dword v113, v[8:9], off
L_pf:
    s_mov_b64 exec, s[92:93]
    s_and_b32 s36, s2, 1
    s_lshr_b32 s47, s2, 1
    s_and_b32 s47, s47, 3
    s_lshr_b32 s48, s2, 3
    s_and_b32 s49, s48, 1
    s_lshl_b32 s38, s47, 1
    s_add_u32 s38, s38, s49
    s_lshr_b32 s37, s48, 1
    v_lshrrev_b32 v8, 6, v0
    v_and_b32 v0, 63, v0
    v_readfirstlane_b32 s39, v8
    v_lshrrev_b32 v254, 4, v0
    v_and_b32 v10, 15, v0
    v_lshlrev_b32 v1, 7, v0
    v_xor_b32 v11, v10, v254
    v_lshlrev_b32_e64 v11, 4, v11
    v_lshl_add_u32 v2, v10, 8, v11
    s_and_b32 s41, s37, 15
    s_and_b32 s47, s41, 3
    s_lshl_b32 s47, s47, 6
    v_xor_b32 v3, s47, v2
    v_lshl_add_u32 v5, v254, 10, v11
    s_mul_i32 s47, s39, 4160
    v_xor_b32 v5, s47, v5
    v_lshlrev_b32 v255, 4, v10
    s_lshl_b32 s40, s38, 2
    s_add_u32 s40, s40, s39
    s_mul_i32 s46, s37, 81920
    s_lshr_b32 s47, s41, 2
    s_lshl_b32 s47, s47, 8
    s_add_u32 s46, s46, s47
    s_lshl_b32 s54, s39, 10
    s_lshl_b32 s52, s40, 8
    s_lshl_b32 s47, s41, 18
    s_add_u32 s52, s52, s47
    s_nop 0
    v_lshl_add_u32 v8, v254, 16, v255
    v_add_u32 v9, 8192, v8
    v_add_u32 v10, 16384, v8
    v_add_u32 v11, 24576, v8
    v_add_u32 v12, 32768, v8
    v_add_u32 v13, 40960, v8
    v_add_u32 v14, 49152, v8
    v_add_u32 v15, 57344, v8
    s_waitcnt lgkmcnt(0)
    s_cmp_eq_u32 s36, 0
    s_cselect_b32 s4, s64, s74
    s_cselect_b32 s5, s65, s75
    s_mov_b32 s6, 1310720
    s_mov_b32 s7, 0x00020000
    s_cselect_b32 s16, s70, s80
    s_cselect_b32 s17, s71, s81
    s_mov_b32 s18, 4194304
    s_mov_b32 s19, 0x00020000
    s_xor_b32 s47, s46, 0
    s_add_u32 m0, s54, 0
    s_add_u32 s49, s47, 0
    s_nop 0
    buffer_load_dwordx4 v5, s[4:7], s49 offen lds
    s_add_u32 m0, s54, 4096
    s_add_u32 s49, s47, 16384
    buffer_load_dwordx4 v5, s[4:7], s49 offen lds
    s_add_u32 m0, s54, 8192
    s_add_u32 s49, s47, 32768
    buffer_load_dwordx4 v5, s[4:7], s49 offen lds
    s_add_u32 m0, s54, 12288
    s_add_u32 s49, s47, 49152
    buffer_load_dwordx4 v5, s[4:7], s49 offen lds
    s_add_u32 m0, s54, 16384
    s_add_u32 s49, s47, 65536
    buffer_load_dwordx4 v5, s[4:7], s49 offen lds
    s_xor_b32 s51, s52, 0
    s_nop 0
    buffer_load_dwordx4 v[16:19], v8, s[16:19], s51 offen
    buffer_load_dwordx4 v[20:23], v9, s[16:19], s51 offen
    buffer_load_dwordx4 v[24:27], v10, s[16:19], s51 offen
    buffer_load_dwordx4 v[28:31], v11, s[16:19], s51 offen
    buffer_load_dwordx4 v[32:35], v12, s[16:19], s51 offen
    buffer_load_dwordx4 v[36:39], v13, s[16:19], s51 offen
    buffer_load_dwordx4 v[40:43], v14, s[16:19], s51 offen
    buffer_load_dwordx4 v[44:47], v15, s[16:19], s51 offen
    s_xor_b32 s51, s52, 262144
    buffer_load_dwordx4 v[48:51], v8, s[16:19], s51 offen
    buffer_load_dwordx4 v[52:55], v9, s[16:19], s51 offen
    buffer_load_dwordx4 v[56:59], v10, s[16:19], s51 offen
    buffer_load_dwordx4 v[60:63], v11, s[16:19], s51 offen
    buffer_load_dwordx4 v[64:67], v12, s[16:19], s51 offen
    buffer_load_dwordx4 v[68:71], v13, s[16:19], s51 offen
    buffer_load_dwordx4 v[72:75], v14, s[16:19], s51 offen
    buffer_load_dwordx4 v[76:79], v15, s[16:19], s51 offen
    s_cmp_eq_u32 s36, 0
    s_cselect_b32 s8, s66, s76
    s_cselect_b32 s9, s67, s77
    s_nop 0
    s_mov_b32 s10, 10485760
    s_mov_b32 s11, 0x00020000
    s_cselect_b32 s12, s68, s78
    s_cselect_b32 s13, s69, s79
    s_mov_b32 s14, 10485760
    s_mov_b32 s15, 0x00020000
    s_cselect_b32 s20, s72, s82
    s_cselect_b32 s21, s73, s83
    s_mov_b32 s22, 4194304
    s_mov_b32 s23, 0x00020000
    s_cselect_b32 s24, s88, s88
    s_cselect_b32 s25, s89, s89
    s_mov_b32 s26, 268435456
    s_mov_b32 s27, 0x00020000
    s_cselect_b32 s28, s84, s84
    s_cselect_b32 s29, s85, s85
    s_mov_b32 s30, 2621440
    s_mov_b32 s31, 0x00020000
    s_cselect_b32 s32, s86, s86
    s_cselect_b32 s33, s87, s87
    s_mov_b32 s34, 256
    s_mov_b32 s35, 0x00020000
    v_and_b32 v116, 15, v0
    v_lshlrev_b32 v114, 2, v254
    v_xor_b32 v114, v114, v116
    v_lshlrev_b32 v114, 4, v114
    v_lshl_add_u32 v248, v254, 8, v114
    v_xor_b32 v249, 16, v248
    v_xor_b32 v250, 32, v248
    v_xor_b32 v251, 48, v248
    v_and_b32 v114, 3, v116
    v_xor_b32 v114, v114, v254
    v_lshrrev_b32 v115, 2, v116
    v_lshl_add_u32 v114, v114, 2, v115
    v_lshlrev_b32_e64 v114, 4, v114
    v_lshl_add_u32 v253, v116, 8, v114
    v_lshrrev_b32 v114, 1, v116
    v_xor_b32 v114, v114, v254
    v_lshlrev_b32 v114, 5, v114
    v_and_b32 v115, 1, v116
    v_lshl_add_u32 v114, v115, 4, v114
    v_lshl_add_u32 v6, v254, 8, v114
    v_xor_b32 v252, 128, v6
    v_lshrrev_b32 v114, 2, v0
    v_and_b32 v115, 7, v114
    v_lshlrev_b32_e64 v115, 5, v115
    v_lshl_add_u32 v115, v114, 8, v115
    v_and_b32_e64 v114, 3, v0
    v_lshl_add_u32 v7, v114, 3, v115
    s_mov_b32 s42, 0x05040100
    s_mov_b32 s43, 0x07060302
    s_mov_b32 s44, 0x3e0293ee
    s_lshl_b32 s45, s37, 5
    s_add_u32 s45, s45, s40
    s_mul_i32 s45, s45, 20480
    s_mul_i32 s53, s39, 20480
    s_add_u32 s53, s53, 81920
    v_add_u32 v7, s53, v7
    v_add_u32 v253, s53, v253
    s_lshl_b32 s55, s36, 4
    s_add_u32 s55, s55, s37
    s_and_b32 s61, s37, 7
    s_mov_b32 s62, 0
    s_lshl_b32 s56, s55, 3
    s_add_u32 s56, s56, s38
    s_lshl_b32 s56, s56, 2
    s_add_u32 s56, s56, s39
    s_mul_i32 s56, s56, 20480
    s_add_u32 s56, s56, 1048576
    s_lshl_b32 s100, s55, 2
    s_add_u32 s100, s100, s39
    s_lshl_b32 s100, s100, 8
    s_nop 0
    s_add_u32 s100, s100, 524288
    s_lshl_b32 s3, s55, 3
    s_nop 0
    v_accvgpr_write_b32 a236, 0
    v_accvgpr_write_b32 a237, 0
    v_accvgpr_write_b32 a238, 0
    v_accvgpr_write_b32 a239, 0
    v_lshlrev_b32_e64 v115, 4, v0
    s_cmp_eq_u32 s40, 0
    s_cselect_b32 s50, s100, 0x40000000
    s_cselect_b32 s63, s3, 0x1000
    buffer_store_dwordx4 a[236:239], v115, s[24:27], s50 offen sc1
    v_accvgpr_write_b32 a232, 1
    v_xor_b32_e64 v4, 0, v3
    s_waitcnt vmcnt(17)
    s_barrier
    ds_read_b128 a[32:35], v4
    ds_read_b128 a[36:39], v4 offset:4096
    ds_read_b128 a[40:43], v4 offset:8192
    ds_read_b128 a[44:47], v4 offset:12288
    ds_read_b128 a[48:51], v4 offset:16384
    s_xor_b32 s51, s52, 524288
    buffer_load_dwordx4 v[80:83], v8, s[16:19], s51 offen
    buffer_load_dwordx4 v[84:87], v9, s[16:19], s51 offen
    buffer_load_dwordx4 v[88:91], v10, s[16:19], s51 offen
    buffer_load_dwordx4 v[92:95], v11, s[16:19], s51 offen
    buffer_load_dwordx4 v[96:99], v12, s[16:19], s51 offen
    buffer_load_dwordx4 v[100:103], v13, s[16:19], s51 offen
    buffer_load_dwordx4 v[104:107], v14, s[16:19], s51 offen
    buffer_load_dwordx4 v[108:111], v15, s[16:19], s51 offen
    s_cmp_eq_u32 s61, 0
    s_cbranch_scc1 L_oK0
L_rK0:
    s_cmp_eq_u32 s62, 0
    s_cbranch_scc1 L_cda0
    s_sub_u32 s62, s62, 1
    s_waitcnt vmcnt(37)
    s_branch L_cdb0
L_cda0:
    s_waitcnt vmcnt(17)
L_cdb0:
    v_perm_b32 v112, v20, v16, s42
    v_perm_b32 v113, v28, v24, s42
    v_perm_b32 v114, v36, v32, s42
    v_perm_b32 v115, v44, v40, s42
    s_waitcnt lgkmcnt(0)
    s_nop 0
    v_mfma_f32_16x16x32_bf16 v[120:123], v[112:115], a[32:35], 0
    v_perm_b32 v116, v20, v16, s43
    v_perm_b32 v117, v28, v24, s43
    v_mfma_f32_16x16x32_bf16 v[152:155], v[112:115], a[36:39], 0
    v_perm_b32 v118, v36, v32, s43
    v_perm_b32 v119, v44, v40, s43
    v_mfma_f32_16x16x32_bf16 v[184:187], v[112:115], a[40:43], 0
    s_xor_b32 s47, s46, 256
    s_add_u32 m0, s54, 20480
    s_add_u32 s49, s47, 0
    s_nop 0
    buffer_load_dwordx4 v5, s[4:7], s49 offen lds
    v_mfma_f32_16x16x32_bf16 v[216:219], v[112:115], a[44:47], 0
    s_add_u32 m0, s54, 24576
    s_add_u32 s49, s47, 16384
    buffer_load_dwordx4 v5, s[4:7], s49 offen lds
    v_mfma_f32_16x16x32_bf16 a[0:3], v[112:115], a[48:51], 0
    v_xor_b32_e64 v4, 64, v3
    ds_read_b128 a[52:55], v4
    v_mfma_f32_16x16x32_bf16 v[124:127], v[116:119], a[32:35], 0
    v_perm_b32 v112, v21, v17, s42
    v_perm_b32 v113, v29, v25, s42
    v_mfma_f32_16x16x32_bf16 v[156:159], v[116:119], a[36:39], 0
    v_perm_b32 v114, v37, v33, s42
    v_perm_b32 v115, v45, v41, s42
    v_mfma_f32_16x16x32_bf16 v[188:191], v[116:119], a[40:43], 0
    s_add_u32 m0, s54, 28672
    s_add_u32 s49, s47, 32768
    buffer_load_dwordx4 v5, s[4:7], s49 offen lds
    v_mfma_f32_16x16x32_bf16 v[220:223], v[116:119], a[44:47], 0
    s_add_u32 m0, s54, 32768
    s_add_u32 s49, s47, 49152
    buffer_load_dwordx4 v5, s[4:7], s49 offen lds
    v_mfma_f32_16x16x32_bf16 a[4:7], v[116:119], a[48:51], 0
    ds_read_b128 a[56:59], v4 offset:4096
    v_mfma_f32_16x16x32_bf16 v[128:131], v[112:115], a[32:35], 0
    v_perm_b32 v116, v21, v17, s43
    v_perm_b32 v117, v29, v25, s43
    v_mfma_f32_16x16x32_bf16 v[160:163], v[112:115], a[36:39], 0
    v_perm_b32 v118, v37, v33, s43
    v_perm_b32 v119, v45, v41, s43
    v_mfma_f32_16x16x32_bf16 v[192:195], v[112:115], a[40:43], 0
    s_add_u32 m0, s54, 36864
    s_add_u32 s49, s47, 65536
    buffer_load_dwordx4 v5, s[4:7], s49 offen lds
    v_mfma_f32_16x16x32_bf16 v[224:227], v[112:115], a[44:47], 0
    v_mfma_f32_16x16x32_bf16 a[8:11], v[112:115], a[48:51], 0
    ds_read_b128 a[60:63], v4 offset:8192
    v_mfma_f32_16x16x32_bf16 v[132:135], v[116:119], a[32:35], 0
    v_perm_b32 v112, v22, v18, s42
    v_perm_b32 v113, v30, v26, s42
    v_mfma_f32_16x16x32_bf16 v[164:167], v[116:119], a[36:39], 0
    v_perm_b32 v114, v38, v34, s42
    v_perm_b32 v115, v46, v42, s42
    v_mfma_f32_16x16x32_bf16 v[196:199], v[116:119], a[40:43], 0
    s_cmp_eq_u32 s61, 1
    s_cbranch_scc1 L_oK1
L_rK1:
    s_xor_b32 s47, s46, 512
    s_add_u32 m0, s54, 40960
    s_add_u32 s49, s47, 0
    s_nop 0
    buffer_load_dwordx4 v5, s[4:7], s49 offen lds
    v_mfma_f32_16x16x32_bf16 v[228:231], v[116:119], a[44:47], 0
    v_mfma_f32_16x16x32_bf16 a[12:15], v[116:119], a[48:51], 0
    ds_read_b128 a[64:67], v4 offset:12288
    v_mfma_f32_16x16x32_bf16 v[136:139], v[112:115], a[32:35], 0
    v_perm_b32 v116, v22, v18, s43
    v_perm_b32 v117, v30, v26, s43
    v_mfma_f32_16x16x32_bf16 v[168:171], v[112:115], a[36:39], 0
    v_perm_b32 v118, v38, v34, s43
    v_perm_b32 v119, v46, v42, s43
    v_mfma_f32_16x16x32_bf16 v[200:203], v[112:115], a[40:43], 0
    s_add_u32 m0, s54, 45056
    s_add_u32 s49, s47, 16384
    buffer_load_dwordx4 v5, s[4:7], s49 offen lds
    v_mfma_f32_16x16x32_bf16 v[232:235], v[112:115], a[44:47], 0
    v_mfma_f32_16x16x32_bf16 a[16:19], v[112:115], a[48:51], 0
    ds_read_b128 a[68:71], v4 offset:16384
    v_mfma_f32_16x16x32_bf16 v[140:143], v[116:119], a[32:35], 0
    v_perm_b32 v112, v23, v19, s42
    v_perm_b32 v113, v31, v27, s42
    v_mfma_f32_16x16x32_bf16 v[172:175], v[116:119], a[36:39], 0
    v_perm_b32 v114, v39, v35, s42
    v_perm_b32 v115, v47, v43, s42
    v_mfma_f32_16x16x32_bf16 v[204:207], v[116:119], a[40:43], 0
    s_add_u32 m0, s54, 49152
    s_add_u32 s49, s47, 32768
    buffer_load_dwordx4 v5, s[4:7], s49 offen lds
    v_mfma_f32_16x16x32_bf16 v[236:239], v[116:119], a[44:47], 0
    v_mfma_f32_16x16x32_bf16 a[20:23], v[116:119], a[48:51], 0
    v_mfma_f32_16x16x32_bf16 v[144:147], v[112:115], a[32:35], 0
    v_perm_b32 v116, v23, v19, s43
    v_perm_b32 v117, v31, v27, s43
    v_mfma_f32_16x16x32_bf16 v[176:179], v[112:115], a[36:39], 0
    v_perm_b32 v118, v39, v35, s43
    v_perm_b32 v119, v47, v43, s43
    v_mfma_f32_16x16x32_bf16 v[208:211], v[112:115], a[40:43], 0
    s_add_u32 m0, s54, 53248
    s_add_u32 s49, s47, 49152
    buffer_load_dwordx4 v5, s[4:7], s49 offen lds
    v_mfma_f32_16x16x32_bf16 v[240:243], v[112:115], a[44:47], 0
    v_mfma_f32_16x16x32_bf16 a[24:27], v[112:115], a[48:51], 0
    v_mfma_f32_16x16x32_bf16 v[148:151], v[116:119], a[32:35], 0
    s_cmp_eq_u32 s62, 0
    s_cbranch_scc1 L_cda1
    s_sub_u32 s62, s62, 1
    s_waitcnt vmcnt(38)
    s_branch L_cdb1
L_cda1:
    s_waitcnt vmcnt(18)
L_cdb1:
    v_perm_b32 v112, v52, v48, s42
    v_perm_b32 v113, v60, v56, s42
    v_mfma_f32_16x16x32_bf16 v[180:183], v[116:119], a[36:39], 0
    v_perm_b32 v114, v68, v64, s42
    v_perm_b32 v115, v76, v72, s42
    v_mfma_f32_16x16x32_bf16 v[212:215], v[116:119], a[40:43], 0
    s_xor_b32 s51, s52, 786432
    buffer_load_dwordx4 v[16:19], v8, s[16:19], s51 offen
    s_add_u32 m0, s54, 57344
    s_add_u32 s49, s47, 65536
    buffer_load_dwordx4 v5, s[4:7], s49 offen lds
    v_mfma_f32_16x16x32_bf16 v[244:247], v[116:119], a[44:47], 0
    buffer_load_dwordx4 v[20:23], v9, s[16:19], s51 offen
    v_mfma_f32_16x16x32_bf16 a[28:31], v[116:119], a[48:51], 0
    s_waitcnt lgkmcnt(0)
    s_nop 0
    v_mfma_f32_16x16x32_bf16 v[120:123], v[112:115], a[52:55], v[120:123]
    v_perm_b32 v116, v52, v48, s43
    v_perm_b32 v117, v60, v56, s43
    v_mfma_f32_16x16x32_bf16 v[152:155], v[112:115], a[56:59], v[152:155]
    v_perm_b32 v118, v68, v64, s43
    v_perm_b32 v119, v76, v72, s43
    v_mfma_f32_16x16x32_bf16 v[184:187], v[112:115], a[60:63], v[184:187]
    buffer_load_dwordx4 v[24:27], v10, s[16:19], s51 offen
    v_mfma_f32_16x16x32_bf16 v[216:219], v[112:115], a[64:67], v[216:219]
    buffer_load_dwordx4 v[28:31], v11, s[16:19], s51 offen
    v_mfma_f32_16x16x32_bf16 a[0:3], v[112:115], a[68:71], a[0:3]
    v_xor_b32 v4, 128, v3
    ds_read_b128 a[32:35], v4
    v_mfma_f32_16x16x32_bf16 v[124:127], v[116:119], a[52:55], v[124:127]
    v_perm_b32 v112, v53, v49, s42
    v_perm_b32 v113, v61, v57, s42
    v_mfma_f32_16x16x32_bf16 v[156:159], v[116:119], a[56:59], v[156:159]
    v_perm_b32 v114, v69, v65, s42
    v_perm_b32 v115, v77, v73, s42
    v_mfma_f32_16x16x32_bf16 v[188:191], v[116:119], a[60:63], v[188:191]
    buffer_load_dwordx4 v[32:35], v12, s[16:19], s51 offen
    v_mfma_f32_16x16x32_bf16 v[220:223], v[116:119], a[64:67], v[220:223]
    buffer_load_dwordx4 v[36:39], v13, s[16:19], s51 offen
    v_mfma_f32_16x16x32_bf16 a[4:7], v[116:119], a[68:71], a[4:7]
    ds_read_b128 a[36:39], v4 offset:4096
    v_mfma_f32_16x16x32_bf16 v[128:131], v[112:115], a[52:55], v[128:131]
    v_perm_b32 v116, v53, v49, s43
    v_perm_b32 v117, v61, v57, s43
    v_mfma_f32_16x16x32_bf16 v[160:163], v[112:115], a[56:59], v[160:163]
    v_perm_b32 v118, v69, v65, s43
    v_perm_b32 v119, v77, v73, s43
    v_mfma_f32_16x16x32_bf16 v[192:195], v[112:115], a[60:63], v[192:195]
    buffer_load_dwordx4 v[40:43], v14, s[16:19], s51 offen
    v_mfma_f32_16x16x32_bf16 v[224:227], v[112:115], a[64:67], v[224:227]
    buffer_load_dwordx4 v[44:47], v15, s[16:19], s51 offen
    v_mfma_f32_16x16x32_bf16 a[8:11], v[112:115], a[68:71], a[8:11]
    ds_read_b128 a[40:43], v4 offset:8192
    v_mfma_f32_16x16x32_bf16 v[132:135], v[116:119], a[52:55], v[132:135]
    v_perm_b32 v112, v54, v50, s42
    v_perm_b32 v113, v62, v58, s42
    v_mfma_f32_16x16x32_bf16 v[164:167], v[116:119], a[56:59], v[164:167]
    v_perm_b32 v114, v70, v66, s42
    v_perm_b32 v115, v78, v74, s42
    v_mfma_f32_16x16x32_bf16 v[196:199], v[116:119], a[60:63], v[196:199]
    s_cmp_eq_u32 s61, 2
    s_cbranch_scc1 L_oK2
L_rK2:
    v_mfma_f32_16x16x32_bf16 v[228:231], v[116:119], a[64:67], v[228:231]
    v_mfma_f32_16x16x32_bf16 a[12:15], v[116:119], a[68:71], a[12:15]
    ds_read_b128 a[44:47], v4 offset:12288
    v_mfma_f32_16x16x32_bf16 v[136:139], v[112:115], a[52:55], v[136:139]
    v_perm_b32 v116, v54, v50, s43
    v_perm_b32 v117, v62, v58, s43
    v_mfma_f32_16x16x32_bf16 v[168:171], v[112:115], a[56:59], v[168:171]
    v_perm_b32 v118, v70, v66, s43
    v_perm_b32 v119, v78, v74, s43
    v_mfma_f32_16x16x32_bf16 v[200:203], v[112:115], a[60:63], v[200:203]
    v_mfma_f32_16x16x32_bf16 v[232:235], v[112:115], a[64:67], v[232:235]
    v_mfma_f32_16x16x32_bf16 a[16:19], v[112:115], a[68:71], a[16:19]
    ds_read_b128 a[48:51], v4 offset:16384
    v_mfma_f32_16x16x32_bf16 v[140:143], v[116:119], a[52:55], v[140:143]
    v_perm_b32 v112, v55, v51, s42
    v_perm_b32 v113, v63, v59, s42
    v_mfma_f32_16x16x32_bf16 v[172:175], v[116:119], a[56:59], v[172:175]
    v_perm_b32 v114, v71, v67, s42
    v_perm_b32 v115, v79, v75, s42
    v_mfma_f32_16x16x32_bf16 v[204:207], v[116:119], a[60:63], v[204:207]
    v_mfma_f32_16x16x32_bf16 v[236:239], v[116:119], a[64:67], v[236:239]
    v_mfma_f32_16x16x32_bf16 a[20:23], v[116:119], a[68:71], a[20:23]
    v_mfma_f32_16x16x32_bf16 v[144:147], v[112:115], a[52:55], v[144:147]
    v_perm_b32 v116, v55, v51, s43
    v_perm_b32 v117, v63, v59, s43
    v_mfma_f32_16x16x32_bf16 v[176:179], v[112:115], a[56:59], v[176:179]
    v_perm_b32 v118, v71, v67, s43
    v_perm_b32 v119, v79, v75, s43
    v_mfma_f32_16x16x32_bf16 v[208:211], v[112:115], a[60:63], v[208:211]
    v_mfma_f32_16x16x32_bf16 v[240:243], v[112:115], a[64:67], v[240:243]
    v_mfma_f32_16x16x32_bf16 a[24:27], v[112:115], a[68:71], a[24:27]
    v_mfma_f32_16x16x32_bf16 v[148:151], v[116:119], a[52:55], v[148:151]
    s_cmp_eq_u32 s62, 0
    s_cbranch_scc1 L_cda2
    s_sub_u32 s62, s62, 1
    s_waitcnt vmcnt(38)
    s_branch L_cdb2
L_cda2:
    s_waitcnt vmcnt(18)
L_cdb2:
    v_perm_b32 v112, v84, v80, s42
    v_perm_b32 v113, v92, v88, s42
    v_mfma_f32_16x16x32_bf16 v[180:183], v[116:119], a[56:59], v[180:183]
    v_perm_b32 v114, v100, v96, s42
    v_perm_b32 v115, v108, v104, s42
    v_mfma_f32_16x16x32_bf16 v[212:215], v[116:119], a[60:63], v[212:215]
    s_xor_b32 s51, s52, 1048576
    buffer_load_dwordx4 v[48:51], v8, s[16:19], s51 offen
    v_mfma_f32_16x16x32_bf16 v[244:247], v[116:119], a[64:67], v[244:247]
    buffer_load_dwordx4 v[52:55], v9, s[16:19], s51 offen
    v_mfma_f32_16x16x32_bf16 a[28:31], v[116:119], a[68:71], a[28:31]
    s_waitcnt lgkmcnt(0)
    s_nop 0
    v_mfma_f32_16x16x32_bf16 v[120:123], v[112:115], a[32:35], v[120:123]
    v_perm_b32 v116, v84, v80, s43
    v_perm_b32 v117, v92, v88, s43
    v_mfma_f32_16x16x32_bf16 v[152:155], v[112:115], a[36:39], v[152:155]
    v_perm_b32 v118, v100, v96, s43
    v_perm_b32 v119, v108, v104, s43
    v_mfma_f32_16x16x32_bf16 v[184:187], v[112:115], a[40:43], v[184:187]
    buffer_load_dwordx4 v[56:59], v10, s[16:19], s51 offen
    v_mfma_f32_16x16x32_bf16 v[216:219], v[112:115], a[44:47], v[216:219]
    buffer_load_dwordx4 v[60:63], v11, s[16:19], s51 offen
    v_mfma_f32_16x16x32_bf16 a[0:3], v[112:115], a[48:51], a[0:3]
    v_xor_b32 v4, 192, v3
    ds_read_b128 a[52:55], v4
    v_mfma_f32_16x16x32_bf16 v[124:127], v[116:119], a[32:35], v[124:127]
    v_perm_b32 v112, v85, v81, s42
    v_perm_b32 v113, v93, v89, s42
    v_mfma_f32_16x16x32_bf16 v[156:159], v[116:119], a[36:39], v[156:159]
    v_perm_b32 v114, v101, v97, s42
    v_perm_b32 v115, v109, v105, s42
    v_mfma_f32_16x16x32_bf16 v[188:191], v[116:119], a[40:43], v[188:191]
    buffer_load_dwordx4 v[64:67], v12, s[16:19], s51 offen
    v_mfma_f32_16x16x32_bf16 v[220:223], v[116:119], a[44:47], v[220:223]
    buffer_load_dwordx4 v[68:71], v13, s[16:19], s51 offen
    v_mfma_f32_16x16x32_bf16 a[4:7], v[116:119], a[48:51], a[4:7]
    ds_read_b128 a[56:59], v4 offset:4096
    v_mfma_f32_16x16x32_bf16 v[128:131], v[112:115], a[32:35], v[128:131]
    v_perm_b32 v116, v85, v81, s43
    v_perm_b32 v117, v93, v89, s43
    v_mfma_f32_16x16x32_bf16 v[160:163], v[112:115], a[36:39], v[160:163]
    v_perm_b32 v118, v101, v97, s43
    v_perm_b32 v119, v109, v105, s43
    v_mfma_f32_16x16x32_bf16 v[192:195], v[112:115], a[40:43], v[192:195]
    buffer_load_dwordx4 v[72:75], v14, s[16:19], s51 offen
    v_mfma_f32_16x16x32_bf16 v[224:227], v[112:115], a[44:47], v[224:227]
    buffer_load_dwordx4 v[76:79], v15, s[16:19], s51 offen
    v_mfma_f32_16x16x32_bf16 a[8:11], v[112:115], a[48:51], a[8:11]
    ds_read_b128 a[60:63], v4 offset:8192
    v_mfma_f32_16x16x32_bf16 v[132:135], v[116:119], a[32:35], v[132:135]
    v_perm_b32 v112, v86, v82, s42
    v_perm_b32 v113, v94, v90, s42
    v_mfma_f32_16x16x32_bf16 v[164:167], v[116:119], a[36:39], v[164:167]
    v_perm_b32 v114, v102, v98, s42
    v_perm_b32 v115, v110, v106, s42
    v_mfma_f32_16x16x32_bf16 v[196:199], v[116:119], a[40:43], v[196:199]
    s_cmp_eq_u32 s61, 3
    s_cbranch_scc1 L_oK3
L_rK3:
    v_mfma_f32_16x16x32_bf16 v[228:231], v[116:119], a[44:47], v[228:231]
    v_mfma_f32_16x16x32_bf16 a[12:15], v[116:119], a[48:51], a[12:15]
    ds_read_b128 a[64:67], v4 offset:12288
    v_mfma_f32_16x16x32_bf16 v[136:139], v[112:115], a[32:35], v[136:139]
    v_perm_b32 v116, v86, v82, s43
    v_perm_b32 v117, v94, v90, s43
    v_mfma_f32_16x16x32_bf16 v[168:171], v[112:115], a[36:39], v[168:171]
    v_perm_b32 v118, v102, v98, s43
    v_perm_b32 v119, v110, v106, s43
    v_mfma_f32_16x16x32_bf16 v[200:203], v[112:115], a[40:43], v[200:203]
    v_mfma_f32_16x16x32_bf16 v[232:235], v[112:115], a[44:47], v[232:235]
    v_mfma_f32_16x16x32_bf16 a[16:19], v[112:115], a[48:51], a[16:19]
    ds_read_b128 a[68:71], v4 offset:16384
    v_mfma_f32_16x16x32_bf16 v[140:143], v[116:119], a[32:35], v[140:143]
    v_perm_b32 v112, v87, v83, s42
    v_perm_b32 v113, v95, v91, s42
    v_mfma_f32_16x16x32_bf16 v[172:175], v[116:119], a[36:39], v[172:175]
    v_perm_b32 v114, v103, v99, s42
    v_perm_b32 v115, v111, v107, s42
    v_mfma_f32_16x16x32_bf16 v[204:207], v[116:119], a[40:43], v[204:207]
    v_mfma_f32_16x16x32_bf16 v[236:239], v[116:119], a[44:47], v[236:239]
    v_mfma_f32_16x16x32_bf16 a[20:23], v[116:119], a[48:51], a[20:23]
    v_mfma_f32_16x16x32_bf16 v[144:147], v[112:115], a[32:35], v[144:147]
    v_perm_b32 v116, v87, v83, s43
    v_perm_b32 v117, v95, v91, s43
    v_mfma_f32_16x16x32_bf16 v[176:179], v[112:115], a[36:39], v[176:179]
    v_perm_b32 v118, v103, v99, s43
    v_perm_b32 v119, v111, v107, s43
    v_mfma_f32_16x16x32_bf16 v[208:211], v[112:115], a[40:43], v[208:211]
    v_mfma_f32_16x16x32_bf16 v[240:243], v[112:115], a[44:47], v[240:243]
    v_mfma_f32_16x16x32_bf16 a[24:27], v[112:115], a[48:51], a[24:27]
    v_mfma_f32_16x16x32_bf16 v[148:151], v[116:119], a[32:35], v[148:151]
    s_cmp_eq_u32 s62, 0
    s_cbranch_scc1 L_cda3
    s_sub_u32 s62, s62, 1
    s_waitcnt vmcnt(28)
    s_branch L_cdb3
L_cda3:
    s_waitcnt vmcnt(8)
L_cdb3:
    v_perm_b32 v112, v20, v16, s42
    v_perm_b32 v113, v28, v24, s42
    v_mfma_f32_16x16x32_bf16 v[180:183], v[116:119], a[36:39], v[180:183]
    v_perm_b32 v114, v36, v32, s42
    v_perm_b32 v115, v44, v40, s42
    v_mfma_f32_16x16x32_bf16 v[212:215], v[116:119], a[40:43], v[212:215]
    s_xor_b32 s51, s52, 1310720
    buffer_load_dwordx4 v[80:83], v8, s[16:19], s51 offen
    v_mfma_f32_16x16x32_bf16 v[244:247], v[116:119], a[44:47], v[244:247]
    buffer_load_dwordx4 v[84:87], v9, s[16:19], s51 offen
    v_mfma_f32_16x16x32_bf16 a[28:31], v[116:119], a[48:51], a[28:31]
    s_waitcnt lgkmcnt(0)
    s_nop 0
    v_mfma_f32_16x16x32_bf16 v[120:123], v[112:115], a[52:55], v[120:123]
    v_perm_b32 v116, v20, v16, s43
    v_perm_b32 v117, v28, v24, s43
    v_mfma_f32_16x16x32_bf16 v[152:155], v[112:115], a[56:59], v[152:155]
    v_perm_b32 v118, v36, v32, s43
    v_perm_b32 v119, v44, v40, s43
    v_mfma_f32_16x16x32_bf16 v[184:187], v[112:115], a[60:63], v[184:187]
    buffer_load_dwordx4 v[88:91], v10, s[16:19], s51 offen
    v_mfma_f32_16x16x32_bf16 v[216:219], v[112:115], a[64:67], v[216:219]
    buffer_load_dwordx4 v[92:95], v11, s[16:19], s51 offen
    v_mfma_f32_16x16x32_bf16 a[0:3], v[112:115], a[68:71], a[0:3]
    s_barrier
    s_nop 0
    v_xor_b32 v4, 20480, v3
    ds_read_b128 a[32:35], v4
    v_mfma_f32_16x16x32_bf16 v[124:127], v[116:119], a[52:55], v[124:127]
    v_perm_b32 v112, v21, v17, s42
    v_perm_b32 v113, v29, v25, s42
    v_mfma_f32_16x16x32_bf16 v[156:159], v[116:119], a[56:59], v[156:159]
    v_perm_b32 v114, v37, v33, s42
    v_perm_b32 v115, v45, v41, s42
    v_mfma_f32_16x16x32_bf16 v[188:191], v[116:119], a[60:63], v[188:191]
    buffer_load_dwordx4 v[96:99], v12, s[16:19], s51 offen
    v_mfma_f32_16x16x32_bf16 v[220:223], v[116:119], a[64:67], v[220:223]
    buffer_load_dwordx4 v[100:103], v13, s[16:19], s51 offen
    v_mfma_f32_16x16x32_bf16 a[4:7], v[116:119], a[68:71], a[4:7]
    ds_read_b128 a[36:39], v4 offset:4096
    v_mfma_f32_16x16x32_bf16 v[128:131], v[112:115], a[52:55], v[128:131]
    v_perm_b32 v116, v21, v17, s43
    v_perm_b32 v117, v29, v25, s43
    v_mfma_f32_16x16x32_bf16 v[160:163], v[112:115], a[56:59], v[160:163]
    v_perm_b32 v118, v37, v33, s43
    v_perm_b32 v119, v45, v41, s43
    v_mfma_f32_16x16x32_bf16 v[192:195], v[112:115], a[60:63], v[192:195]
    buffer_load_dwordx4 v[104:107], v14, s[16:19], s51 offen
    v_mfma_f32_16x16x32_bf16 v[224:227], v[112:115], a[64:67], v[224:227]
    buffer_load_dwordx4 v[108:111], v15, s[16:19], s51 offen
    v_mfma_f32_16x16x32_bf16 a[8:11], v[112:115], a[68:71], a[8:11]
    ds_read_b128 a[40:43], v4 offset:8192
    v_mfma_f32_16x16x32_bf16 v[132:135], v[116:119], a[52:55], v[132:135]
    v_perm_b32 v112, v22, v18, s42
    v_perm_b32 v113, v30, v26, s42
    v_mfma_f32_16x16x32_bf16 v[164:167], v[116:119], a[56:59], v[164:167]
    v_perm_b32 v114, v38, v34, s42
    v_perm_b32 v115, v46, v42, s42
    v_mfma_f32_16x16x32_bf16 v[196:199], v[116:119], a[60:63], v[196:199]
    s_cmp_eq_u32 s61, 4
    s_cbranch_scc1 L_oK4
L_rK4:
    v_mfma_f32_16x16x32_bf16 v[228:231], v[116:119], a[64:67], v[228:231]
    v_mfma_f32_16x16x32_bf16 a[12:15], v[116:119], a[68:71], a[12:15]
    ds_read_b128 a[44:47], v4 offset:12288
    v_mfma_f32_16x16x32_bf16 v[136:139], v[112:115], a[52:55], v[136:139]
    v_perm_b32 v116, v22, v18, s43
    v_perm_b32 v117, v30, v26, s43
    v_mfma_f32_16x16x32_bf16 v[168:171], v[112:115], a[56:59], v[168:171]
    v_perm_b32 v118, v38, v34, s43
    v_perm_b32 v119, v46, v42, s43
    v_mfma_f32_16x16x32_bf16 v[200:203], v[112:115], a[60:63], v[200:203]
    v_mfma_f32_16x16x32_bf16 v[232:235], v[112:115], a[64:67], v[232:235]
    v_mfma_f32_16x16x32_bf16 a[16:19], v[112:115], a[68:71], a[16:19]
    ds_read_b128 a[48:51], v4 offset:16384
    v_mfma_f32_16x16x32_bf16 v[140:143], v[116:119], a[52:55], v[140:143]
    v_perm_b32 v112, v23, v19, s42
    v_perm_b32 v113, v31, v27, s42
    v_mfma_f32_16x16x32_bf16 v[172:175], v[116:119], a[56:59], v[172:175]
    v_perm_b32 v114, v39, v35, s42
    v_perm_b32 v115, v47, v43, s42
    v_mfma_f32_16x16x32_bf16 v[204:207], v[116:119], a[60:63], v[204:207]
    v_mfma_f32_16x16x32_bf16 v[236:239], v[116:119], a[64:67], v[236:239]
    v_mfma_f32_16x16x32_bf16 a[20:23], v[116:119], a[68:71], a[20:23]
    v_mfma_f32_16x16x32_bf16 v[144:147], v[112:115], a[52:55], v[144:147]
    v_perm_b32 v116, v23, v19, s43
    v_perm_b32 v117, v31, v27, s43
    v_mfma_f32_16x16x32_bf16 v[176:179], v[112:115], a[56:59], v[176:179]
    v_perm_b32 v118, v39, v35, s43
    v_perm_b32 v119, v47, v43, s43
    v_mfma_f32_16x16x32_bf16 v[208:211], v[112:115], a[60:63], v[208:211]
    v_mfma_f32_16x16x32_bf16 v[240:243], v[112:115], a[64:67], v[240:243]
    v_mfma_f32_16x16x32_bf16 a[24:27], v[112:115], a[68:71], a[24:27]
    v_mfma_f32_16x16x32_bf16 v[148:151], v[116:119], a[52:55], v[148:151]
    s_cmp_eq_u32 s62, 0
    s_cbranch_scc1 L_cda4
    s_sub_u32 s62, s62, 1
    s_waitcnt vmcnt(28)
    s_branch L_cdb4
L_cda4:
    s_waitcnt vmcnt(8)
L_cdb4:
    v_perm_b32 v112, v52, v48, s42
    v_perm_b32 v113, v60, v56, s42
    v_mfma_f32_16x16x32_bf16 v[180:183], v[116:119], a[56:59], v[180:183]
    v_perm_b32 v114, v68, v64, s42
    v_perm_b32 v115, v76, v72, s42
    v_mfma_f32_16x16x32_bf16 v[212:215], v[116:119], a[60:63], v[212:215]
    s_xor_b32 s51, s52, 1572864
    buffer_load_dwordx4 v[16:19], v8, s[16:19], s51 offen
    v_mfma_f32_16x16x32_bf16 v[244:247], v[116:119], a[64:67], v[244:247]
    buffer_load_dwordx4 v[20:23], v9, s[16:19], s51 offen
    v_mfma_f32_16x16x32_bf16 a[28:31], v[116:119], a[68:71], a[28:31]
    s_waitcnt lgkmcnt(0)
    s_nop 0
    v_mfma_f32_16x16x32_bf16 v[120:123], v[112:115], a[32:35], v[120:123]
    v_perm_b32 v116, v52, v48, s43
    v_perm_b32 v117, v60, v56, s43
    v_mfma_f32_16x16x32_bf16 v[152:155], v[112:115], a[36:39], v[152:155]
    v_perm_b32 v118, v68, v64, s43
    v_perm_b32 v119, v76, v72, s43
    v_mfma_f32_16x16x32_bf16 v[184:187], v[112:115], a[40:43], v[184:187]
    buffer_load_dwordx4 v[24:27], v10, s[16:19], s51 offen
    v_mfma_f32_16x16x32_bf16 v[216:219], v[112:115], a[44:47], v[216:219]
    buffer_load_dwordx4 v[28:31], v11, s[16:19], s51 offen
    v_mfma_f32_16x16x32_bf16 a[0:3], v[112:115], a[48:51], a[0:3]
    v_xor_b32 v4, 20544, v3
    ds_read_b128 a[52:55], v4
    v_mfma_f32_16x16x32_bf16 v[124:127], v[116:119], a[32:35], v[124:127]
    v_perm_b32 v112, v53, v49, s42
    v_perm_b32 v113, v61, v57, s42
    v_mfma_f32_16x16x32_bf16 v[156:159], v[116:119], a[36:39], v[156:159]
    v_perm_b32 v114, v69, v65, s42
    v_perm_b32 v115, v77, v73, s42
    v_mfma_f32_16x16x32_bf16 v[188:191], v[116:119], a[40:43], v[188:191]
    buffer_load_dwordx4 v[32:35], v12, s[16:19], s51 offen
    v_mfma_f32_16x16x32_bf16 v[220:223], v[116:119], a[44:47], v[220:223]
    buffer_load_dwordx4 v[36:39], v13, s[16:19], s51 offen
    v_mfma_f32_16x16x32_bf16 a[4:7], v[116:119], a[48:51], a[4:7]
    ds_read_b128 a[56:59], v4 offset:4096
    v_mfma_f32_16x16x32_bf16 v[128:131], v[112:115], a[32:35], v[128:131]
    v_perm_b32 v116, v53, v49, s43
    v_perm_b32 v117, v61, v57, s43
    v_mfma_f32_16x16x32_bf16 v[160:163], v[112:115], a[36:39], v[160:163]
    v_perm_b32 v118, v69, v65, s43
    v_perm_b32 v119, v77, v73, s43
    v_mfma_f32_16x16x32_bf16 v[192:195], v[112:115], a[40:43], v[192:195]
    buffer_load_dwordx4 v[40:43], v14, s[16:19], s51 offen
    v_mfma_f32_16x16x32_bf16 v[224:227], v[112:115], a[44:47], v[224:227]
    buffer_load_dwordx4 v[44:47], v15, s[16:19], s51 offen
    v_mfma_f32_16x16x32_bf16 a[8:11], v[112:115], a[48:51], a[8:11]
    ds_read_b128 a[60:63], v4 offset:8192
    v_mfma_f32_16x16x32_bf16 v[132:135], v[116:119], a[32:35], v[132:135]
    v_perm_b32 v112, v54, v50, s42
    v_perm_b32 v113, v62, v58, s42
    v_mfma_f32_16x16x32_bf16 v[164:167], v[116:119], a[36:39], v[164:167]
    v_perm_b32 v114, v70, v66, s42
    v_perm_b32 v115, v78, v74, s42
    v_mfma_f32_16x16x32_bf16 v[196:199], v[116:119], a[40:43], v[196:199]
    s_cmp_eq_u32 s61, 5
    s_cbranch_scc1 L_oK5
L_rK5:
    v_mfma_f32_16x16x32_bf16 v[228:231], v[116:119], a[44:47], v[228:231]
    v_mfma_f32_16x16x32_bf16 a[12:15], v[116:119], a[48:51], a[12:15]
    ds_read_b128 a[64:67], v4 offset:12288
    v_mfma_f32_16x16x32_bf16 v[136:139], v[112:115], a[32:35], v[136:139]
    v_perm_b32 v116, v54, v50, s43
    v_perm_b32 v117, v62, v58, s43
    v_mfma_f32_16x16x32_bf16 v[168:171], v[112:115], a[36:39], v[168:171]
    v_perm_b32 v118, v70, v66, s43
    v_perm_b32 v119, v78, v74, s43
    v_mfma_f32_16x16x32_bf16 v[200:203], v[112:115], a[40:43], v[200:203]
    v_mfma_f32_16x16x32_bf16 v[232:235], v[112:115], a[44:47], v[232:235]
    v_mfma_f32_16x16x32_bf16 a[16:19], v[112:115], a[48:51], a[16:19]
    ds_read_b128 a[68:71], v4 offset:16384
    v_mfma_f32_16x16x32_bf16 v[140:143], v[116:119], a[32:35], v[140:143]
    v_perm_b32 v112, v55, v51, s42
    v_perm_b32 v113, v63, v59, s42
    v_mfma_f32_16x16x32_bf16 v[172:175], v[116:119], a[36:39], v[172:175]
    v_perm_b32 v114, v71, v67, s42
    v_perm_b32 v115, v79, v75, s42
    v_mfma_f32_16x16x32_bf16 v[204:207], v[116:119], a[40:43], v[204:207]
    v_mfma_f32_16x16x32_bf16 v[236:239], v[116:119], a[44:47], v[236:239]
    v_mfma_f32_16x16x32_bf16 a[20:23], v[116:119], a[48:51], a[20:23]
    v_mfma_f32_16x16x32_bf16 v[144:147], v[112:115], a[32:35], v[144:147]
    v_perm_b32 v116, v55, v51, s43
    v_perm_b32 v117, v63, v59, s43
    v_mfma_f32_16x16x32_bf16 v[176:179], v[112:115], a[36:39], v[176:179]
    v_perm_b32 v118, v71, v67, s43
    v_perm_b32 v119, v79, v75, s43
    v_mfma_f32_16x16x32_bf16 v[208:211], v[112:115], a[40:43], v[208:211]
    v_mfma_f32_16x16x32_bf16 v[240:243], v[112:115], a[44:47], v[240:243]
    v_mfma_f32_16x16x32_bf16 a[24:27], v[112:115], a[48:51], a[24:27]
    v_mfma_f32_16x16x32_bf16 v[148:151], v[116:119], a[32:35], v[148:151]
    s_cmp_eq_u32 s62, 0
    s_cbranch_scc1 L_cda5
    s_sub_u32 s62, s62, 1
    s_waitcnt vmcnt(28)
    s_branch L_cdb5
L_cda5:
    s_waitcnt vmcnt(8)
L_cdb5:
    v_perm_b32 v112, v84, v80, s42
    v_perm_b32 v113, v92, v88, s42
    v_mfma_f32_16x16x32_bf16 v[180:183], v[116:119], a[36:39], v[180:183]
    v_perm_b32 v114, v100, v96, s42
    v_perm_b32 v115, v108, v104, s42
    v_mfma_f32_16x16x32_bf16 v[212:215], v[116:119], a[40:43], v[212:215]
    s_xor_b32 s51, s52, 1835008
    buffer_load_dwordx4 v[48:51], v8, s[16:19], s51 offen
    v_mfma_f32_16x16x32_bf16 v[244:247], v[116:119], a[44:47], v[244:247]
    buffer_load_dwordx4 v[52:55], v9, s[16:19], s51 offen
    v_mfma_f32_16x16x32_bf16 a[28:31], v[116:119], a[48:51], a[28:31]
    s_waitcnt lgkmcnt(0)
    s_nop 0
    v_mfma_f32_16x16x32_bf16 v[120:123], v[112:115], a[52:55], v[120:123]
    v_perm_b32 v116, v84, v80, s43
    v_perm_b32 v117, v92, v88, s43
    v_mfma_f32_16x16x32_bf16 v[152:155], v[112:115], a[56:59], v[152:155]
    v_perm_b32 v118, v100, v96, s43
    v_perm_b32 v119, v108, v104, s43
    v_mfma_f32_16x16x32_bf16 v[184:187], v[112:115], a[60:63], v[184:187]
    buffer_load_dwordx4 v[56:59], v10, s[16:19], s51 offen
    v_mfma_f32_16x16x32_bf16 v[216:219], v[112:115], a[64:67], v[216:219]
    buffer_load_dwordx4 v[60:63], v11, s[16:19], s51 offen
    v_mfma_f32_16x16x32_bf16 a[0:3], v[112:115], a[68:71], a[0:3]
    v_xor_b32 v4, 20608, v3
    ds_read_b128 a[32:35], v4
    v_mfma_f32_16x16x32_bf16 v[124:127], v[116:119], a[52:55], v[124:127]
    v_perm_b32 v112, v85, v81, s42
    v_perm_b32 v113, v93, v89, s42
    v_mfma_f32_16x16x32_bf16 v[156:159], v[116:119], a[56:59], v[156:159]
    v_perm_b32 v114, v101, v97, s42
    v_perm_b32 v115, v109, v105, s42
    v_mfma_f32_16x16x32_bf16 v[188:191], v[116:119], a[60:63], v[188:191]
    buffer_load_dwordx4 v[64:67], v12, s[16:19], s51 offen
    v_mfma_f32_16x16x32_bf16 v[220:223], v[116:119], a[64:67], v[220:223]
    buffer_load_dwordx4 v[68:71], v13, s[16:19], s51 offen
    v_mfma_f32_16x16x32_bf16 a[4:7], v[116:119], a[68:71], a[4:7]
    ds_read_b128 a[36:39], v4 offset:4096
    v_mfma_f32_16x16x32_bf16 v[128:131], v[112:115], a[52:55], v[128:131]
    v_perm_b32 v116, v85, v81, s43
    v_perm_b32 v117, v93, v89, s43
    v_mfma_f32_16x16x32_bf16 v[160:163], v[112:115], a[56:59], v[160:163]
    v_perm_b32 v118, v101, v97, s43
    v_perm_b32 v119, v109, v105, s43
    v_mfma_f32_16x16x32_bf16 v[192:195], v[112:115], a[60:63], v[192:195]
    buffer_load_dwordx4 v[72:75], v14, s[16:19], s51 offen
    v_mfma_f32_16x16x32_bf16 v[224:227], v[112:115], a[64:67], v[224:227]
    buffer_load_dwordx4 v[76:79], v15, s[16:19], s51 offen
    v_mfma_f32_16x16x32_bf16 a[8:11], v[112:115], a[68:71], a[8:11]
    ds_read_b128 a[40:43], v4 offset:8192
    v_mfma_f32_16x16x32_bf16 v[132:135], v[116:119], a[52:55], v[132:135]
    v_perm_b32 v112, v86, v82, s42
    v_perm_b32 v113, v94, v90, s42
    v_mfma_f32_16x16x32_bf16 v[164:167], v[116:119], a[56:59], v[164:167]
    v_perm_b32 v114, v102, v98, s42
    v_perm_b32 v115, v110, v106, s42
    v_mfma_f32_16x16x32_bf16 v[196:199], v[116:119], a[60:63], v[196:199]
    s_cmp_eq_u32 s61, 6
    s_cbranch_scc1 L_oK6
L_rK6:
    v_mfma_f32_16x16x32_bf16 v[228:231], v[116:119], a[64:67], v[228:231]
    v_mfma_f32_16x16x32_bf16 a[12:15], v[116:119], a[68:71], a[12:15]
    ds_read_b128 a[44:47], v4 offset:12288
    v_mfma_f32_16x16x32_bf16 v[136:139], v[112:115], a[52:55], v[136:139]
    v_perm_b32 v116, v86, v82, s43
    v_perm_b32 v117, v94, v90, s43
    v_mfma_f32_16x16x32_bf16 v[168:171], v[112:115], a[56:59], v[168:171]
    v_perm_b32 v118, v102, v98, s43
    v_perm_b32 v119, v110, v106, s43
    v_mfma_f32_16x16x32_bf16 v[200:203], v[112:115], a[60:63], v[200:203]
    v_mfma_f32_16x16x32_bf16 v[232:235], v[112:115], a[64:67], v[232:235]
    v_mfma_f32_16x16x32_bf16 a[16:19], v[112:115], a[68:71], a[16:19]
    ds_read_b128 a[48:51], v4 offset:16384
    v_mfma_f32_16x16x32_bf16 v[140:143], v[116:119], a[52:55], v[140:143]
    v_perm_b32 v112, v87, v83, s42
    v_perm_b32 v113, v95, v91, s42
    v_mfma_f32_16x16x32_bf16 v[172:175], v[116:119], a[56:59], v[172:175]
    v_perm_b32 v114, v103, v99, s42
    v_perm_b32 v115, v111, v107, s42
    v_mfma_f32_16x16x32_bf16 v[204:207], v[116:119], a[60:63], v[204:207]
    v_mfma_f32_16x16x32_bf16 v[236:239], v[116:119], a[64:67], v[236:239]
    v_mfma_f32_16x16x32_bf16 a[20:23], v[116:119], a[68:71], a[20:23]
    v_mfma_f32_16x16x32_bf16 v[144:147], v[112:115], a[52:55], v[144:147]
    v_perm_b32 v116, v87, v83, s43
    v_perm_b32 v117, v95, v91, s43
    v_mfma_f32_16x16x32_bf16 v[176:179], v[112:115], a[56:59], v[176:179]
    v_perm_b32 v118, v103, v99, s43
    v_perm_b32 v119, v111, v107, s43
    v_mfma_f32_16x16x32_bf16 v[208:211], v[112:115], a[60:63], v[208:211]
    v_mfma_f32_16x16x32_bf16 v[240:243], v[112:115], a[64:67], v[240:243]
    v_mfma_f32_16x16x32_bf16 a[24:27], v[112:115], a[68:71], a[24:27]
    v_mfma_f32_16x16x32_bf16 v[148:151], v[116:119], a[52:55], v[148:151]
    s_cmp_eq_u32 s62, 0
    s_cbranch_scc1 L_cda6
    s_sub_u32 s62, s62, 1
    s_waitcnt vmcnt(28)
    s_branch L_cdb6
L_cda6:
    s_waitcnt vmcnt(8)
L_cdb6:
    v_perm_b32 v112, v20, v16, s42
    v_perm_b32 v113, v28, v24, s42
    v_mfma_f32_16x16x32_bf16 v[180:183], v[116:119], a[56:59], v[180:183]
    v_perm_b32 v114, v36, v32, s42
    v_perm_b32 v115, v44, v40, s42
    v_mfma_f32_16x16x32_bf16 v[212:215], v[116:119], a[60:63], v[212:215]
    s_xor_b32 s51, s52, 2097152
    buffer_load_dwordx4 v[80:83], v8, s[16:19], s51 offen
    v_mfma_f32_16x16x32_bf16 v[244:247], v[116:119], a[64:67], v[244:247]
    buffer_load_dwordx4 v[84:87], v9, s[16:19], s51 offen
    v_mfma_f32_16x16x32_bf16 a[28:31], v[116:119], a[68:71], a[28:31]
    s_waitcnt lgkmcnt(0)
    s_nop 0
    v_mfma_f32_16x16x32_bf16 v[120:123], v[112:115], a[32:35], v[120:123]
    v_perm_b32 v116, v20, v16, s43
    v_perm_b32 v117, v28, v24, s43
    v_mfma_f32_16x16x32_bf16 v[152:155], v[112:115], a[36:39], v[152:155]
    v_perm_b32 v118, v36, v32, s43
    v_perm_b32 v119, v44, v40, s43
    v_mfma_f32_16x16x32_bf16 v[184:187], v[112:115], a[40:43], v[184:187]
    buffer_load_dwordx4 v[88:91], v10, s[16:19], s51 offen
    v_mfma_f32_16x16x32_bf16 v[216:219], v[112:115], a[44:47], v[216:219]
    buffer_load_dwordx4 v[92:95], v11, s[16:19], s51 offen
    v_mfma_f32_16x16x32_bf16 a[0:3], v[112:115], a[48:51], a[0:3]
    v_xor_b32 v4, 20672, v3
    ds_read_b128 a[52:55], v4
    v_mfma_f32_16x16x32_bf16 v[124:127], v[116:119], a[32:35], v[124:127]
    v_perm_b32 v112, v21, v17, s42
    v_perm_b32 v113, v29, v25, s42
    v_mfma_f32_16x16x32_bf16 v[156:159], v[116:119], a[36:39], v[156:159]
    v_perm_b32 v114, v37, v33, s42
    v_perm_b32 v115, v45, v41, s42
    v_mfma_f32_16x16x32_bf16 v[188:191], v[116:119], a[40:43], v[188:191]
    buffer_load_dwordx4 v[96:99], v12, s[16:19], s51 offen
    v_mfma_f32_16x16x32_bf16 v[220:223], v[116:119], a[44:47], v[220:223]
    buffer_load_dwordx4 v[100:103], v13, s[16:19], s51 offen
    v_mfma_f32_16x16x32_bf16 a[4:7], v[116:119], a[48:51], a[4:7]
    ds_read_b128 a[56:59], v4 offset:4096
    v_mfma_f32_16x16x32_bf16 v[128:131], v[112:115], a[32:35], v[128:131]
    v_perm_b32 v116, v21, v17, s43
    v_perm_b32 v117, v29, v25, s43
    v_mfma_f32_16x16x32_bf16 v[160:163], v[112:115], a[36:39], v[160:163]
    v_perm_b32 v118, v37, v33, s43
    v_perm_b32 v119, v45, v41, s43
    v_mfma_f32_16x16x32_bf16 v[192:195], v[112:115], a[40:43], v[192:195]
    buffer_load_dwordx4 v[104:107], v14, s[16:19], s51 offen
    v_mfma_f32_16x16x32_bf16 v[224:227], v[112:115], a[44:47], v[224:227]
    buffer_load_dwordx4 v[108:111], v15, s[16:19], s51 offen
    v_mfma_f32_16x16x32_bf16 a[8:11], v[112:115], a[48:51], a[8:11]
    ds_read_b128 a[60:63], v4 offset:8192
    v_mfma_f32_16x16x32_bf16 v[132:135], v[116:119], a[32:35], v[132:135]
    v_perm_b32 v112, v22, v18, s42
    v_perm_b32 v113, v30, v26, s42
    v_mfma_f32_16x16x32_bf16 v[164:167], v[116:119], a[36:39], v[164:167]
    v_perm_b32 v114, v38, v34, s42
    v_perm_b32 v115, v46, v42, s42
    v_mfma_f32_16x16x32_bf16 v[196:199], v[116:119], a[40:43], v[196:199]
    s_cmp_eq_u32 s61, 7
    s_cbranch_scc1 L_oK7
L_rK7:
    v_mfma_f32_16x16x32_bf16 v[228:231], v[116:119], a[44:47], v[228:231]
    v_mfma_f32_16x16x32_bf16 a[12:15], v[116:119], a[48:51], a[12:15]
    ds_read_b128 a[64:67], v4 offset:12288
    v_mfma_f32_16x16x32_bf16 v[136:139], v[112:115], a[32:35], v[136:139]
    v_perm_b32 v116, v22, v18, s43
    v_perm_b32 v117, v30, v26, s43
    v_mfma_f32_16x16x32_bf16 v[168:171], v[112:115], a[36:39], v[168:171]
    v_perm_b32 v118, v38, v34, s43
    v_perm_b32 v119, v46, v42, s43
    v_mfma_f32_16x16x32_bf16 v[200:203], v[112:115], a[40:43], v[200:203]
    v_mfma_f32_16x16x32_bf16 v[232:235], v[112:115], a[44:47], v[232:235]
    v_mfma_f32_16x16x32_bf16 a[16:19], v[112:115], a[48:51], a[16:19]
    ds_read_b128 a[68:71], v4 offset:16384
    v_mfma_f32_16x16x32_bf16 v[140:143], v[116:119], a[32:35], v[140:143]
    v_perm_b32 v112, v23, v19, s42
    v_perm_b32 v113, v31, v27, s42
    v_mfma_f32_16x16x32_bf16 v[172:175], v[116:119], a[36:39], v[172:175]
    v_perm_b32 v114, v39, v35, s42
    v_perm_b32 v115, v47, v43, s42
    v_mfma_f32_16x16x32_bf16 v[204:207], v[116:119], a[40:43], v[204:207]
    v_mfma_f32_16x16x32_bf16 v[236:239], v[116:119], a[44:47], v[236:239]
    v_mfma_f32_16x16x32_bf16 a[20:23], v[116:119], a[48:51], a[20:23]
    v_mfma_f32_16x16x32_bf16 v[144:147], v[112:115], a[32:35], v[144:147]
    v_perm_b32 v116, v23, v19, s43
    v_perm_b32 v117, v31, v27, s43
    v_mfma_f32_16x16x32_bf16 v[176:179], v[112:115], a[36:39], v[176:179]
    v_perm_b32 v118, v39, v35, s43
    v_perm_b32 v119, v47, v43, s43
    v_mfma_f32_16x16x32_bf16 v[208:211], v[112:115], a[40:43], v[208:211]
    v_mfma_f32_16x16x32_bf16 v[240:243], v[112:115], a[44:47], v[240:243]
    v_mfma_f32_16x16x32_bf16 a[24:27], v[112:115], a[48:51], a[24:27]
    v_mfma_f32_16x16x32_bf16 v[148:151], v[116:119], a[32:35], v[148:151]
    s_cmp_eq_u32 s62, 0
    s_cbranch_scc1 L_cda7
    s_sub_u32 s62, s62, 1
    s_waitcnt vmcnt(28)
    s_branch L_cdb7
L_cda7:
    s_waitcnt vmcnt(8)
L_cdb7:
    v_perm_b32 v112, v52, v48, s42
    v_perm_b32 v113, v60, v56, s42
    v_mfma_f32_16x16x32_bf16 v[180:183], v[116:119], a[36:39], v[180:183]
    v_perm_b32 v114, v68, v64, s42
    v_perm_b32 v115, v76, v72, s42
    v_mfma_f32_16x16x32_bf16 v[212:215], v[116:119], a[40:43], v[212:215]
    s_xor_b32 s51, s52, 2359296
    buffer_load_dwordx4 v[16:19], v8, s[16:19], s51 offen
    v_mfma_f32_16x16x32_bf16 v[244:247], v[116:119], a[44:47], v[244:247]
    buffer_load_dwordx4 v[20:23], v9, s[16:19], s51 offen
    v_mfma_f32_16x16x32_bf16 a[28:31], v[116:119], a[48:51], a[28:31]
    s_waitcnt lgkmcnt(0)
    s_nop 0
    v_mfma_f32_16x16x32_bf16 v[120:123], v[112:115], a[52:55], v[120:123]
    v_perm_b32 v116, v52, v48, s43
    v_perm_b32 v117, v60, v56, s43
    v_mfma_f32_16x16x32_bf16 v[152:155], v[112:115], a[56:59], v[152:155]
    v_perm_b32 v118, v68, v64, s43
    v_perm_b32 v119, v76, v72, s43
    v_mfma_f32_16x16x32_bf16 v[184:187], v[112:115], a[60:63], v[184:187]
    buffer_load_dwordx4 v[24:27], v10, s[16:19], s51 offen
    v_mfma_f32_16x16x32_bf16 v[216:219], v[112:115], a[64:67], v[216:219]
    buffer_load_dwordx4 v[28:31], v11, s[16:19], s51 offen
    v_mfma_f32_16x16x32_bf16 a[0:3], v[112:115], a[68:71], a[0:3]
    v_xor_b32 v4, 40960, v3
    ds_read_b128 a[32:35], v4
    v_mfma_f32_16x16x32_bf16 v[124:127], v[116:119], a[52:55], v[124:127]
    v_perm_b32 v112, v53, v49, s42
    v_perm_b32 v113, v61, v57, s42
    v_mfma_f32_16x16x32_bf16 v[156:159], v[116:119], a[56:59], v[156:159]
    v_perm_b32 v114, v69, v65, s42
    v_perm_b32 v115, v77, v73, s42
    v_mfma_f32_16x16x32_bf16 v[188:191], v[116:119], a[60:63], v[188:191]
    buffer_load_dwordx4 v[32:35], v12, s[16:19], s51 offen
    v_mfma_f32_16x16x32_bf16 v[220:223], v[116:119], a[64:67], v[220:223]
    buffer_load_dwordx4 v[36:39], v13, s[16:19], s51 offen
    v_mfma_f32_16x16x32_bf16 a[4:7], v[116:119], a[68:71], a[4:7]
    ds_read_b128 a[36:39], v4 offset:4096
    v_mfma_f32_16x16x32_bf16 v[128:131], v[112:115], a[52:55], v[128:131]
    v_perm_b32 v116, v53, v49, s43
    v_perm_b32 v117, v61, v57, s43
    v_mfma_f32_16x16x32_bf16 v[160:163], v[112:115], a[56:59], v[160:163]
    v_perm_b32 v118, v69, v65, s43
    v_perm_b32 v119, v77, v73, s43
    v_mfma_f32_16x16x32_bf16 v[192:195], v[112:115], a[60:63], v[192:195]
    buffer_load_dwordx4 v[40:43], v14, s[16:19], s51 offen
    v_mfma_f32_16x16x32_bf16 v[224:227], v[112:115], a[64:67], v[224:227]
    buffer_load_dwordx4 v[44:47], v15, s[16:19], s51 offen
    v_mfma_f32_16x16x32_bf16 a[8:11], v[112:115], a[68:71], a[8:11]
    ds_read_b128 a[40:43], v4 offset:8192
    v_mfma_f32_16x16x32_bf16 v[132:135], v[116:119], a[52:55], v[132:135]
    v_perm_b32 v112, v54, v50, s42
    v_perm_b32 v113, v62, v58, s42
    v_mfma_f32_16x16x32_bf16 v[164:167], v[116:119], a[56:59], v[164:167]
    v_perm_b32 v114, v70, v66, s42
    v_perm_b32 v115, v78, v74, s42
    v_mfma_f32_16x16x32_bf16 v[196:199], v[116:119], a[60:63], v[196:199]
    s_xor_b32 s47, s46, 768
    s_add_u32 m0, s54, 61440
    s_add_u32 s49, s47, 0
    s_nop 0
    buffer_load_dwordx4 v5, s[4:7], s49 offen lds
    v_mfma_f32_16x16x32_bf16 v[228:231], v[116:119], a[64:67], v[228:231]
    v_mfma_f32_16x16x32_bf16 a[12:15], v[116:119], a[68:71], a[12:15]
    ds_read_b128 a[44:47], v4 offset:12288
    v_mfma_f32_16x16x32_bf16 v[136:139], v[112:115], a[52:55], v[136:139]
    v_perm_b32 v116, v54, v50, s43
    v_perm_b32 v117, v62, v58, s43
    v_mfma_f32_16x16x32_bf16 v[168:171], v[112:115], a[56:59], v[168:171]
    v_perm_b32 v118, v70, v66, s43
    v_perm_b32 v119, v78, v74, s43
    v_mfma_f32_16x16x32_bf16 v[200:203], v[112:115], a[60:63], v[200:203]
    s_add_u32 m0, s54, 65536
    s_add_u32 s49, s47, 16384
    buffer_load_dwordx4 v5, s[4:7], s49 offen lds
    v_mfma_f32_16x16x32_bf16 v[232:235], v[112:115], a[64:67], v[232:235]
    v_mfma_f32_16x16x32_bf16 a[16:19], v[112:115], a[68:71], a[16:19]
    ds_read_b128 a[48:51], v4 offset:16384
    v_mfma_f32_16x16x32_bf16 v[140:143], v[116:119], a[52:55], v[140:143]
    v_perm_b32 v112, v55, v51, s42
    v_perm_b32 v113, v63, v59, s42
    v_mfma_f32_16x16x32_bf16 v[172:175], v[116:119], a[56:59], v[172:175]
    v_perm_b32 v114, v71, v67, s42
    v_perm_b32 v115, v79, v75, s42
    v_mfma_f32_16x16x32_bf16 v[204:207], v[116:119], a[60:63], v[204:207]
    s_add_u32 m0, s54, 69632
    s_add_u32 s49, s47, 32768
    buffer_load_dwordx4 v5, s[4:7], s49 offen lds
    v_mfma_f32_16x16x32_bf16 v[236:239], v[116:119], a[64:67], v[236:239]
    v_mfma_f32_16x16x32_bf16 a[20:23], v[116:119], a[68:71], a[20:23]
    v_mfma_f32_16x16x32_bf16 v[144:147], v[112:115], a[52:55], v[144:147]
    v_perm_b32 v116, v55, v51, s43
    v_perm_b32 v117, v63, v59, s43
    v_mfma_f32_16x16x32_bf16 v[176:179], v[112:115], a[56:59], v[176:179]
    v_perm_b32 v118, v71, v67, s43
    v_perm_b32 v119, v79, v75, s43
    v_mfma_f32_16x16x32_bf16 v[208:211], v[112:115], a[60:63], v[208:211]
    s_add_u32 m0, s54, 73728
    s_add_u32 s49, s47, 49152
    buffer_load_dwordx4 v5, s[4:7], s49 offen lds
    v_mfma_f32_16x16x32_bf16 v[240:243], v[112:115], a[64:67], v[240:243]
    v_mfma_f32_16x16x32_bf16 a[24:27], v[112:115], a[68:71], a[24:27]
    v_mfma_f32_16x16x32_bf16 v[148:151], v[116:119], a[52:55], v[148:151]
    s_cmp_eq_u32 s62, 0
    s_cbranch_scc1 L_cda8
    s_sub_u32 s62, s62, 1
    s_waitcnt vmcnt(32)
    s_branch L_cdb8
L_cda8:
    s_waitcnt vmcnt(12)
L_cdb8:
    v_perm_b32 v112, v84, v80, s42
    v_perm_b32 v113, v92, v88, s42
    v_mfma_f32_16x16x32_bf16 v[180:183], v[116:119], a[56:59], v[180:183]
    v_perm_b32 v114, v100, v96, s42
    v_perm_b32 v115, v108, v104, s42
    v_mfma_f32_16x16x32_bf16 v[212:215], v[116:119], a[60:63], v[212:215]
    s_xor_b32 s51, s52, 2621440
    buffer_load_dwordx4 v[48:51], v8, s[16:19], s51 offen
    s_add_u32 m0, s54, 77824
    s_add_u32 s49, s47, 65536
    buffer_load_dwordx4 v5, s[4:7], s49 offen lds
    v_mfma_f32_16x16x32_bf16 v[244:247], v[116:119], a[64:67], v[244:247]
    buffer_load_dwordx4 v[52:55], v9, s[16:19], s51 offen
    v_mfma_f32_16x16x32_bf16 a[28:31], v[116:119], a[68:71], a[28:31]
    s_waitcnt lgkmcnt(0)
    s_nop 0
    v_mfma_f32_16x16x32_bf16 v[120:123], v[112:115], a[32:35], v[120:123]
    v_perm_b32 v116, v84, v80, s43
    v_perm_b32 v117, v92, v88, s43
    v_mfma_f32_16x16x32_bf16 v[152:155], v[112:115], a[36:39], v[152:155]
    v_perm_b32 v118, v100, v96, s43
    v_perm_b32 v119, v108, v104, s43
    v_mfma_f32_16x16x32_bf16 v[184:187], v[112:115], a[40:43], v[184:187]
    buffer_load_dwordx4 v[56:59], v10, s[16:19], s51 offen
    v_mfma_f32_16x16x32_bf16 v[216:219], v[112:115], a[44:47], v[216:219]
    buffer_load_dwordx4 v[60:63], v11, s[16:19], s51 offen
    v_mfma_f32_16x16x32_bf16 a[0:3], v[112:115], a[48:51], a[0:3]
    v_xor_b32 v4, 41024, v3
    ds_read_b128 a[52:55], v4
    v_mfma_f32_16x16x32_bf16 v[124:127], v[116:119], a[32:35], v[124:127]
    v_perm_b32 v112, v85, v81, s42
    v_perm_b32 v113, v93, v89, s42
    v_mfma_f32_16x16x32_bf16 v[156:159], v[116:119], a[36:39], v[156:159]
    v_perm_b32 v114, v101, v97, s42
    v_perm_b32 v115, v109, v105, s42
    v_mfma_f32_16x16x32_bf16 v[188:191], v[116:119], a[40:43], v[188:191]
    buffer_load_dwordx4 v[64:67], v12, s[16:19], s51 offen
    v_mfma_f32_16x16x32_bf16 v[220:223], v[116:119], a[44:47], v[220:223]
    buffer_load_dwordx4 v[68:71], v13, s[16:19], s51 offen
    v_mfma_f32_16x16x32_bf16 a[4:7], v[116:119], a[48:51], a[4:7]
    ds_read_b128 a[56:59], v4 offset:4096
    v_mfma_f32_16x16x32_bf16 v[128:131], v[112:115], a[32:35], v[128:131]
    v_perm_b32 v116, v85, v81, s43
    v_perm_b32 v117, v93, v89, s43
    v_mfma_f32_16x16x32_bf16 v[160:163], v[112:115], a[36:39], v[160:163]
    v_perm_b32 v118, v101, v97, s43
    v_perm_b32 v119, v109, v105, s43
    v_mfma_f32_16x16x32_bf16 v[192:195], v[112:115], a[40:43], v[192:195]
    buffer_load_dwordx4 v[72:75], v14, s[16:19], s51 offen
    v_mfma_f32_16x16x32_bf16 v[224:227], v[112:115], a[44:47], v[224:227]
    buffer_load_dwordx4 v[76:79], v15, s[16:19], s51 offen
    v_mfma_f32_16x16x32_bf16 a[8:11], v[112:115], a[48:51], a[8:11]
    ds_read_b128 a[60:63], v4 offset:8192
    v_mfma_f32_16x16x32_bf16 v[132:135], v[116:119], a[32:35], v[132:135]
    v_perm_b32 v112, v86, v82, s42
    v_perm_b32 v113, v94, v90, s42
    v_mfma_f32_16x16x32_bf16 v[164:167], v[116:119], a[36:39], v[164:167]
    v_perm_b32 v114, v102, v98, s42
    v_perm_b32 v115, v110, v106, s42
    v_mfma_f32_16x16x32_bf16 v[196:199], v[116:119], a[40:43], v[196:199]
    v_mfma_f32_16x16x32_bf16 v[228:231], v[116:119], a[44:47], v[228:231]
    v_mfma_f32_16x16x32_bf16 a[12:15], v[116:119], a[48:51], a[12:15]
    ds_read_b128 a[64:67], v4 offset:12288
    v_mfma_f32_16x16x32_bf16 v[136:139], v[112:115], a[32:35], v[136:139]
    v_perm_b32 v116, v86, v82, s43
    v_perm_b32 v117, v94, v90, s43
    v_mfma_f32_16x16x32_bf16 v[168:171], v[112:115], a[36:39], v[168:171]
    v_perm_b32 v118, v102, v98, s43
    v_perm_b32 v119, v110, v106, s43
    v_mfma_f32_16x16x32_bf16 v[200:203], v[112:115], a[40:43], v[200:203]
    v_mfma_f32_16x16x32_bf16 v[232:235], v[112:115], a[44:47], v[232:235]
    v_mfma_f32_16x16x32_bf16 a[16:19], v[112:115], a[48:51], a[16:19]
    ds_read_b128 a[68:71], v4 offset:16384
    v_mfma_f32_16x16x32_bf16 v[140:143], v[116:119], a[32:35], v[140:143]
    v_perm_b32 v112, v87, v83, s42
    v_perm_b32 v113, v95, v91, s42
    v_mfma_f32_16x16x32_bf16 v[172:175], v[116:119], a[36:39], v[172:175]
    v_perm_b32 v114, v103, v99, s42
    v_perm_b32 v115, v111, v107, s42
    v_mfma_f32_16x16x32_bf16 v[204:207], v[116:119], a[40:43], v[204:207]
    v_mfma_f32_16x16x32_bf16 v[236:239], v[116:119], a[44:47], v[236:239]
    v_mfma_f32_16x16x32_bf16 a[20:23], v[116:119], a[48:51], a[20:23]
    v_mfma_f32_16x16x32_bf16 v[144:147], v[112:115], a[32:35], v[144:147]
    v_perm_b32 v116, v87, v83, s43
    v_perm_b32 v117, v95, v91, s43
    v_mfma_f32_16x16x32_bf16 v[176:179], v[112:115], a[36:39], v[176:179]
    v_perm_b32 v118, v103, v99, s43
    v_perm_b32 v119, v111, v107, s43
    v_mfma_f32_16x16x32_bf16 v[208:211], v[112:115], a[40:43], v[208:211]
    v_mfma_f32_16x16x32_bf16 v[240:243], v[112:115], a[44:47], v[240:243]
    v_mfma_f32_16x16x32_bf16 a[24:27], v[112:115], a[48:51], a[24:27]
    v_mfma_f32_16x16x32_bf16 v[148:151], v[116:119], a[32:35], v[148:151]
    s_waitcnt vmcnt(13)
    s_nop 0
    v_perm_b32 v112, v20, v16, s42
    v_perm_b32 v113, v28, v24, s42
    v_mfma_f32_16x16x32_bf16 v[180:183], v[116:119], a[36:39], v[180:183]
    v_perm_b32 v114, v36, v32, s42
    v_perm_b32 v115, v44, v40, s42
    v_mfma_f32_16x16x32_bf16 v[212:215], v[116:119], a[40:43], v[212:215]
    s_xor_b32 s51, s52, 2883584
    buffer_load_dwordx4 v[80:83], v8, s[16:19], s51 offen
    v_mfma_f32_16x16x32_bf16 v[244:247], v[116:119], a[44:47], v[244:247]
    buffer_load_dwordx4 v[84:87], v9, s[16:19], s51 offen
    v_mfma_f32_16x16x32_bf16 a[28:31], v[116:119], a[48:51], a[28:31]
    s_waitcnt lgkmcnt(0)
    s_nop 0
    v_mfma_f32_16x16x32_bf16 v[120:123], v[112:115], a[52:55], v[120:123]
    v_perm_b32 v116, v20, v16, s43
    v_perm_b32 v117, v28, v24, s43
    v_mfma_f32_16x16x32_bf16 v[152:155], v[112:115], a[56:59], v[152:155]
    v_perm_b32 v118, v36, v32, s43
    v_perm_b32 v119, v44, v40, s43
    v_mfma_f32_16x16x32_bf16 v[184:187], v[112:115], a[60:63], v[184:187]
    buffer_load_dwordx4 v[88:91], v10, s[16:19], s51 offen
    v_xor_b32_e64 v248, 0, v253
    ds_read_b128 a[72:75], v248
    v_mfma_f32_16x16x32_bf16 v[216:219], v[112:115], a[64:67], v[216:219]
    buffer_load_dwordx4 v[92:95], v11, s[16:19], s51 offen
    ds_read_b128 a[88:91], v248 offset:4096
    v_mfma_f32_16x16x32_bf16 a[0:3], v[112:115], a[68:71], a[0:3]
    v_xor_b32 v4, 41088, v3
    ds_read_b128 a[32:35], v4
    ds_read_b128 a[104:107], v248 offset:8192
    v_mfma_f32_16x16x32_bf16 v[124:127], v[116:119], a[52:55], v[124:127]
    v_perm_b32 v112, v21, v17, s42
    v_perm_b32 v113, v29, v25, s42
    v_mfma_f32_16x16x32_bf16 v[156:159], v[116:119], a[56:59], v[156:159]
    v_perm_b32 v114, v37, v33, s42
    v_perm_b32 v115, v45, v41, s42
    v_mfma_f32_16x16x32_bf16 v[188:191], v[116:119], a[60:63], v[188:191]
    buffer_load_dwordx4 v[96:99], v12, s[16:19], s51 offen
    ds_read_b128 a[120:123], v248 offset:12288
    v_mfma_f32_16x16x32_bf16 v[220:223], v[116:119], a[64:67], v[220:223]
    buffer_load_dwordx4 v[100:103], v13, s[16:19], s51 offen
    ds_read_b128 a[136:139], v248 offset:16384
    v_mfma_f32_16x16x32_bf16 a[4:7], v[116:119], a[68:71], a[4:7]
    ds_read_b128 a[36:39], v4 offset:4096
    v_xor_b32_e64 v249, 16, v253
    ds_read_b128 a[76:79], v249
    v_mfma_f32_16x16x32_bf16 v[128:131], v[112:115], a[52:55], v[128:131]
    v_perm_b32 v116, v21, v17, s43
    v_perm_b32 v117, v29, v25, s43
    v_mfma_f32_16x16x32_bf16 v[160:163], v[112:115], a[56:59], v[160:163]
    v_perm_b32 v118, v37, v33, s43
    v_perm_b32 v119, v45, v41, s43
    v_mfma_f32_16x16x32_bf16 v[192:195], v[112:115], a[60:63], v[192:195]
    buffer_load_dwordx4 v[104:107], v14, s[16:19], s51 offen
    ds_read_b128 a[92:95], v249 offset:4096
    v_mfma_f32_16x16x32_bf16 v[224:227], v[112:115], a[64:67], v[224:227]
    buffer_load_dwordx4 v[108:111], v15, s[16:19], s51 offen
    ds_read_b128 a[108:111], v249 offset:8192
    v_mfma_f32_16x16x32_bf16 a[8:11], v[112:115], a[68:71], a[8:11]
    ds_read_b128 a[40:43], v4 offset:8192
    ds_read_b128 a[124:127], v249 offset:12288
    v_mfma_f32_16x16x32_bf16 v[132:135], v[116:119], a[52:55], v[132:135]
    v_perm_b32 v112, v22, v18, s42
    v_perm_b32 v113, v30, v26, s42
    v_mfma_f32_16x16x32_bf16 v[164:167], v[116:119], a[56:59], v[164:167]
    v_perm_b32 v114, v38, v34, s42
    v_perm_b32 v115, v46, v42, s42
    v_mfma_f32_16x16x32_bf16 v[196:199], v[116:119], a[60:63], v[196:199]
    ds_read_b128 a[140:143], v249 offset:16384
    v_mfma_f32_16x16x32_bf16 v[228:231], v[116:119], a[64:67], v[228:231]
    v_xor_b32_e64 v250, 32, v253
    ds_read_b128 a[80:83], v250
    v_mfma_f32_16x16x32_bf16 a[12:15], v[116:119], a[68:71], a[12:15]
    ds_read_b128 a[44:47], v4 offset:12288
    ds_read_b128 a[96:99], v250 offset:4096
    v_mfma_f32_16x16x32_bf16 v[136:139], v[112:115], a[52:55], v[136:139]
    v_perm_b32 v116, v22, v18, s43
    v_perm_b32 v117, v30, v26, s43
    v_mfma_f32_16x16x32_bf16 v[168:171], v[112:115], a[56:59], v[168:171]
    v_perm_b32 v118, v38, v34, s43
    v_perm_b32 v119, v46, v42, s43
    v_mfma_f32_16x16x32_bf16 v[200:203], v[112:115], a[60:63], v[200:203]
    ds_read_b128 a[112:115], v250 offset:8192
    v_mfma_f32_16x16x32_bf16 v[232:235], v[112:115], a[64:67], v[232:235]
    ds_read_b128 a[128:131], v250 offset:12288
    v_mfma_f32_16x16x32_bf16 a[16:19], v[112:115], a[68:71], a[16:19]
    ds_read_b128 a[48:51], v4 offset:16384
    v_mfma_f32_16x16x32_bf16 v[140:143], v[116:119], a[52:55], v[140:143]
    v_perm_b32 v112, v23, v19, s42
    v_perm_b32 v113, v31, v27, s42
    v_mfma_f32_16x16x32_bf16 v[172:175], v[116:119], a[56:59], v[172:175]
    v_perm_b32 v114, v39, v35, s42
    v_perm_b32 v115, v47, v43, s42
    v_mfma_f32_16x16x32_bf16 v[204:207], v[116:119], a[60:63], v[204:207]
    ds_read_b128 a[144:147], v250 offset:16384
    v_mfma_f32_16x16x32_bf16 v[236:239], v[116:119], a[64:67], v[236:239]
    v_xor_b32_e64 v251, 48, v253
    ds_read_b128 a[84:87], v251
    v_mfma_f32_16x16x32_bf16 a[20:23], v[116:119], a[68:71], a[20:23]
    v_mfma_f32_16x16x32_bf16 v[144:147], v[112:115], a[52:55], v[144:147]
    v_perm_b32 v116, v23, v19, s43
    v_perm_b32 v117, v31, v27, s43
    v_mfma_f32_16x16x32_bf16 v[176:179], v[112:115], a[56:59], v[176:179]
    v_perm_b32 v118, v39, v35, s43
    v_perm_b32 v119, v47, v43, s43
    v_mfma_f32_16x16x32_bf16 v[208:211], v[112:115], a[60:63], v[208:211]
    ds_read_b128 a[100:103], v251 offset:4096
    v_mfma_f32_16x16x32_bf16 v[240:243], v[112:115], a[64:67], v[240:243]
    ds_read_b128 a[116:119], v251 offset:8192
    v_mfma_f32_16x16x32_bf16 a[24:27], v[112:115], a[68:71], a[24:27]
    v_mfma_f32_16x16x32_bf16 v[148:151], v[116:119], a[52:55], v[148:151]
    s_waitcnt vmcnt(8)
    s_nop 0
    v_perm_b32 v112, v52, v48, s42
    v_perm_b32 v113, v60, v56, s42
    v_mfma_f32_16x16x32_bf16 v[180:183], v[116:119], a[56:59], v[180:183]
    v_perm_b32 v114, v68, v64, s42
    v_perm_b32 v115, v76, v72, s42
    v_mfma_f32_16x16x32_bf16 v[212:215], v[116:119], a[60:63], v[212:215]
    s_xor_b32 s51, s52, 3145728
    buffer_load_dwordx4 v[16:19], v8, s[16:19], s51 offen
    ds_read_b128 a[132:135], v251 offset:12288
    v_mfma_f32_16x16x32_bf16 v[244:247], v[116:119], a[64:67], v[244:247]
    buffer_load_dwordx4 v[20:23], v9, s[16:19], s51 offen
    ds_read_b128 a[148:151], v251 offset:16384
    v_mfma_f32_16x16x32_bf16 a[28:31], v[116:119], a[68:71], a[28:31]
    s_waitcnt lgkmcnt(6)
    s_nop 0
    v_mfma_f32_16x16x32_bf16 v[120:123], v[112:115], a[32:35], v[120:123]
    v_perm_b32 v116, v52, v48, s43
    v_perm_b32 v117, v60, v56, s43
    v_mfma_f32_16x16x32_bf16 v[152:155], v[112:115], a[36:39], v[152:155]
    v_perm_b32 v118, v68, v64, s43
    v_perm_b32 v119, v76, v72, s43
    v_mfma_f32_16x16x32_bf16 v[184:187], v[112:115], a[40:43], v[184:187]
    buffer_load_dwordx4 v[24:27], v10, s[16:19], s51 offen
    v_mfma_f32_16x16x32_bf16 v[216:219], v[112:115], a[44:47], v[216:219]
    buffer_load_dwordx4 v[28:31], v11, s[16:19], s51 offen
    v_mfma_f32_16x16x32_bf16 a[0:3], v[112:115], a[48:51], a[0:3]
    v_xor_b32 v4, 41152, v3
    ds_read_b128 a[52:55], v4
    v_mfma_f32_16x16x32_bf16 v[124:127], v[116:119], a[32:35], v[124:127]
    v_perm_b32 v112, v53, v49, s42
    v_perm_b32 v113, v61, v57, s42
    v_mfma_f32_16x16x32_bf16 v[156:159], v[116:119], a[36:39], v[156:159]
    v_perm_b32 v114, v69, v65, s42
    v_perm_b32 v115, v77, v73, s42
    v_mfma_f32_16x16x32_bf16 v[188:191], v[116:119], a[40:43], v[188:191]
    buffer_load_dwordx4 v[32:35], v12, s[16:19], s51 offen
    v_mfma_f32_16x16x32_bf16 v[220:223], v[116:119], a[44:47], v[220:223]
    buffer_load_dwordx4 v[36:39], v13, s[16:19], s51 offen
    v_mfma_f32_16x16x32_bf16 a[4:7], v[116:119], a[48:51], a[4:7]
    ds_read_b128 a[56:59], v4 offset:4096
    v_mfma_f32_16x16x32_bf16 v[128:131], v[112:115], a[32:35], v[128:131]
    v_perm_b32 v116, v53, v49, s43
    v_perm_b32 v117, v61, v57, s43
    v_mfma_f32_16x16x32_bf16 v[160:163], v[112:115], a[36:39], v[160:163]
    v_perm_b32 v118, v69, v65, s43
    v_perm_b32 v119, v77, v73, s43
    v_mfma_f32_16x16x32_bf16 v[192:195], v[112:115], a[40:43], v[192:195]
    buffer_load_dwordx4 v[40:43], v14, s[16:19], s51 offen
    v_mfma_f32_16x16x32_bf16 v[224:227], v[112:115], a[44:47], v[224:227]
    buffer_load_dwordx4 v[44:47], v15, s[16:19], s51 offen
    v_mfma_f32_16x16x32_bf16 a[8:11], v[112:115], a[48:51], a[8:11]
    ds_read_b128 a[60:63], v4 offset:8192
    v_mfma_f32_16x16x32_bf16 v[132:135], v[116:119], a[32:35], v[132:135]
    v_perm_b32 v112, v54, v50, s42
    v_perm_b32 v113, v62, v58, s42
    v_mfma_f32_16x16x32_bf16 v[164:167], v[116:119], a[36:39], v[164:167]
    v_perm_b32 v114, v70, v66, s42
    v_perm_b32 v115, v78, v74, s42
    v_mfma_f32_16x16x32_bf16 v[196:199], v[116:119], a[40:43], v[196:199]
    v_lshlrev_b32_e64 v1, 8, v0
    buffer_store_dword a232, v1, s[32:35], s63 offen sc1
    v_mfma_f32_16x16x32_bf16 v[228:231], v[116:119], a[44:47], v[228:231]
    v_mfma_f32_16x16x32_bf16 a[12:15], v[116:119], a[48:51], a[12:15]
    ds_read_b128 a[64:67], v4 offset:12288
    v_mfma_f32_16x16x32_bf16 v[136:139], v[112:115], a[32:35], v[136:139]
    v_perm_b32 v116, v54, v50, s43
    v_perm_b32 v117, v62, v58, s43
    v_mfma_f32_16x16x32_bf16 v[168:171], v[112:115], a[36:39], v[168:171]
    v_perm_b32 v118, v70, v66, s43
    v_perm_b32 v119, v78, v74, s43
    v_mfma_f32_16x16x32_bf16 v[200:203], v[112:115], a[40:43], v[200:203]
    v_mfma_f32_16x16x32_bf16 v[232:235], v[112:115], a[44:47], v[232:235]
    v_mfma_f32_16x16x32_bf16 a[16:19], v[112:115], a[48:51], a[16:19]
    ds_read_b128 a[68:71], v4 offset:16384
    v_mfma_f32_16x16x32_bf16 v[140:143], v[116:119], a[32:35], v[140:143]
    v_perm_b32 v112, v55, v51, s42
    v_perm_b32 v113, v63, v59, s42
    v_mfma_f32_16x16x32_bf16 v[172:175], v[116:119], a[36:39], v[172:175]
    v_perm_b32 v114, v71, v67, s42
    v_perm_b32 v115, v79, v75, s42
    v_mfma_f32_16x16x32_bf16 v[204:207], v[116:119], a[40:43], v[204:207]
    v_mfma_f32_16x16x32_bf16 v[236:239], v[116:119], a[44:47], v[236:239]
    v_mfma_f32_16x16x32_bf16 a[20:23], v[116:119], a[48:51], a[20:23]
    v_mfma_f32_16x16x32_bf16 v[144:147], v[112:115], a[32:35], v[144:147]
    v_perm_b32 v116, v55, v51, s43
    v_perm_b32 v117, v63, v59, s43
    v_mfma_f32_16x16x32_bf16 v[176:179], v[112:115], a[36:39], v[176:179]
    v_perm_b32 v118, v71, v67, s43
    v_perm_b32 v119, v79, v75, s43
    v_mfma_f32_16x16x32_bf16 v[208:211], v[112:115], a[40:43], v[208:211]
    v_mfma_f32_16x16x32_bf16 v[240:243], v[112:115], a[44:47], v[240:243]
    v_mfma_f32_16x16x32_bf16 a[24:27], v[112:115], a[48:51], a[24:27]
    v_mfma_f32_16x16x32_bf16 v[148:151], v[116:119], a[32:35], v[148:151]
    s_waitcnt vmcnt(9)
    s_nop 0
    v_perm_b32 v112, v84, v80, s42
    v_perm_b32 v113, v92, v88, s42
    v_mfma_f32_16x16x32_bf16 v[180:183], v[116:119], a[36:39], v[180:183]
    v_perm_b32 v114, v100, v96, s42
    v_perm_b32 v115, v108, v104, s42
    v_mfma_f32_16x16x32_bf16 v[212:215], v[116:119], a[40:43], v[212:215]
    s_xor_b32 s51, s52, 3407872
    buffer_load_dwordx4 v[48:51], v8, s[16:19], s51 offen
    v_mfma_f32_16x16x32_bf16 v[244:247], v[116:119], a[44:47], v[244:247]
    buffer_load_dwordx4 v[52:55], v9, s[16:19], s51 offen
    v_mfma_f32_16x16x32_bf16 a[28:31], v[116:119], a[48:51], a[28:31]
    s_waitcnt lgkmcnt(0)
    s_nop 0
    v_mfma_f32_16x16x32_bf16 v[120:123], v[112:115], a[52:55], v[120:123]
    v_perm_b32 v116, v84, v80, s43
    v_perm_b32 v117, v92, v88, s43
    v_mfma_f32_16x16x32_bf16 v[152:155], v[112:115], a[56:59], v[152:155]
    v_perm_b32 v118, v100, v96, s43
    v_perm_b32 v119, v108, v104, s43
    v_mfma_f32_16x16x32_bf16 v[184:187], v[112:115], a[60:63], v[184:187]
    buffer_load_dwordx4 v[56:59], v10, s[16:19], s51 offen
    v_mfma_f32_16x16x32_bf16 v[216:219], v[112:115], a[64:67], v[216:219]
    buffer_load_dwordx4 v[60:63], v11, s[16:19], s51 offen
    v_mfma_f32_16x16x32_bf16 a[0:3], v[112:115], a[68:71], a[0:3]
    s_barrier
    s_nop 0
    v_xor_b32 v4, 61440, v3
    ds_read_b128 a[32:35], v4
    v_mfma_f32_16x16x32_bf16 v[124:127], v[116:119], a[52:55], v[124:127]
    v_perm_b32 v112, v85, v81, s42
    v_perm_b32 v113, v93, v89, s42
    v_mfma_f32_16x16x32_bf16 v[156:159], v[116:119], a[56:59], v[156:159]
    v_perm_b32 v114, v101, v97, s42
    v_perm_b32 v115, v109, v105, s42
    v_mfma_f32_16x16x32_bf16 v[188:191], v[116:119], a[60:63], v[188:191]
    buffer_load_dwordx4 v[64:67], v12, s[16:19], s51 offen
    v_mfma_f32_16x16x32_bf16 v[220:223], v[116:119], a[64:67], v[220:223]
    buffer_load_dwordx4 v[68:71], v13, s[16:19], s51 offen
    v_mfma_f32_16x16x32_bf16 a[4:7], v[116:119], a[68:71], a[4:7]
    ds_read_b128 a[36:39], v4 offset:4096
    v_mfma_f32_16x16x32_bf16 v[128:131], v[112:115], a[52:55], v[128:131]
    v_perm_b32 v116, v85, v81, s43
    v_perm_b32 v117, v93, v89, s43
    v_mfma_f32_16x16x32_bf16 v[160:163], v[112:115], a[56:59], v[160:163]
    v_perm_b32 v118, v101, v97, s43
    v_perm_b32 v119, v109, v105, s43
    v_mfma_f32_16x16x32_bf16 v[192:195], v[112:115], a[60:63], v[192:195]
    buffer_load_dwordx4 v[72:75], v14, s[16:19], s51 offen
    v_mfma_f32_16x16x32_bf16 v[224:227], v[112:115], a[64:67], v[224:227]
    buffer_load_dwordx4 v[76:79], v15, s[16:19], s51 offen
    v_mfma_f32_16x16x32_bf16 a[8:11], v[112:115], a[68:71], a[8:11]
    ds_read_b128 a[40:43], v4 offset:8192
    v_mfma_f32_16x16x32_bf16 v[132:135], v[116:119], a[52:55], v[132:135]
    v_perm_b32 v112, v86, v82, s42
    v_perm_b32 v113, v94, v90, s42
    v_mfma_f32_16x16x32_bf16 v[164:167], v[116:119], a[56:59], v[164:167]
    v_perm_b32 v114, v102, v98, s42
    v_perm_b32 v115, v110, v106, s42
    v_mfma_f32_16x16x32_bf16 v[196:199], v[116:119], a[60:63], v[196:199]
    v_mfma_f32_16x16x32_bf16 v[228:231], v[116:119], a[64:67], v[228:231]
    v_mfma_f32_16x16x32_bf16 a[12:15], v[116:119], a[68:71], a[12:15]
    ds_read_b128 a[44:47], v4 offset:12288
    v_mfma_f32_16x16x32_bf16 v[136:139], v[112:115], a[52:55], v[136:139]
    v_perm_b32 v116, v86, v82, s43
    v_perm_b32 v117, v94, v90, s43
    v_mfma_f32_16x16x32_bf16 v[168:171], v[112:115], a[56:59], v[168:171]
    v_perm_b32 v118, v102, v98, s43
    v_perm_b32 v119, v110, v106, s43
    v_mfma_f32_16x16x32_bf16 v[200:203], v[112:115], a[60:63], v[200:203]
    v_mfma_f32_16x16x32_bf16 v[232:235], v[112:115], a[64:67], v[232:235]
    v_mfma_f32_16x16x32_bf16 a[16:19], v[112:115], a[68:71], a[16:19]
    ds_read_b128 a[48:51], v4 offset:16384
    v_mfma_f32_16x16x32_bf16 v[140:143], v[116:119], a[52:55], v[140:143]
    v_perm_b32 v112, v87, v83, s42
    v_perm_b32 v113, v95, v91, s42
    v_mfma_f32_16x16x32_bf16 v[172:175], v[116:119], a[56:59], v[172:175]
    v_perm_b32 v114, v103, v99, s42
    v_perm_b32 v115, v111, v107, s42
    v_mfma_f32_16x16x32_bf16 v[204:207], v[116:119], a[60:63], v[204:207]
    v_mfma_f32_16x16x32_bf16 v[236:239], v[116:119], a[64:67], v[236:239]
    v_mfma_f32_16x16x32_bf16 a[20:23], v[116:119], a[68:71], a[20:23]
    v_mfma_f32_16x16x32_bf16 v[144:147], v[112:115], a[52:55], v[144:147]
    v_perm_b32 v116, v87, v83, s43
    v_perm_b32 v117, v95, v91, s43
    v_mfma_f32_16x16x32_bf16 v[176:179], v[112:115], a[56:59], v[176:179]
    v_perm_b32 v118, v103, v99, s43
    v_perm_b32 v119, v111, v107, s43
    v_mfma_f32_16x16x32_bf16 v[208:211], v[112:115], a[60:63], v[208:211]
    v_mfma_f32_16x16x32_bf16 v[240:243], v[112:115], a[64:67], v[240:243]
    v_mfma_f32_16x16x32_bf16 a[24:27], v[112:115], a[68:71], a[24:27]
    v_mfma_f32_16x16x32_bf16 v[148:151], v[116:119], a[52:55], v[148:151]
    s_waitcnt vmcnt(9)
    s_nop 0
    v_perm_b32 v112, v20, v16, s42
    v_perm_b32 v113, v28, v24, s42
    v_mfma_f32_16x16x32_bf16 v[180:183], v[116:119], a[56:59], v[180:183]
    v_perm_b32 v114, v36, v32, s42
    v_perm_b32 v115, v44, v40, s42
    v_mfma_f32_16x16x32_bf16 v[212:215], v[116:119], a[60:63], v[212:215]
    s_xor_b32 s51, s52, 3670016
    buffer_load_dwordx4 v[80:83], v8, s[16:19], s51 offen
    v_mfma_f32_16x16x32_bf16 v[244:247], v[116:119], a[64:67], v[244:247]
    buffer_load_dwordx4 v[84:87], v9, s[16:19], s51 offen
    v_mfma_f32_16x16x32_bf16 a[28:31], v[116:119], a[68:71], a[28:31]
    s_waitcnt lgkmcnt(0)
    s_nop 0
    v_mfma_f32_16x16x32_bf16 v[120:123], v[112:115], a[32:35], v[120:123]
    v_perm_b32 v116, v20, v16, s43
    v_perm_b32 v117, v28, v24, s43
    v_mfma_f32_16x16x32_bf16 v[152:155], v[112:115], a[36:39], v[152:155]
    v_perm_b32 v118, v36, v32, s43
    v_perm_b32 v119, v44, v40, s43
    v_mfma_f32_16x16x32_bf16 v[184:187], v[112:115], a[40:43], v[184:187]
    buffer_load_dwordx4 v[88:91], v10, s[16:19], s51 offen
    v_mfma_f32_16x16x32_bf16 v[216:219], v[112:115], a[44:47], v[216:219]
    buffer_load_dwordx4 v[92:95], v11, s[16:19], s51 offen
    v_mfma_f32_16x16x32_bf16 a[0:3], v[112:115], a[48:51], a[0:3]
    v_xor_b32 v4, 61504, v3
    ds_read_b128 a[52:55], v4
    v_mfma_f32_16x16x32_bf16 v[124:127], v[116:119], a[32:35], v[124:127]
    v_perm_b32 v112, v21, v17, s42
    v_perm_b32 v113, v29, v25, s42
    v_mfma_f32_16x16x32_bf16 v[156:159], v[116:119], a[36:39], v[156:159]
    v_perm_b32 v114, v37, v33, s42
    v_perm_b32 v115, v45, v41, s42
    v_mfma_f32_16x16x32_bf16 v[188:191], v[116:119], a[40:43], v[188:191]
    buffer_load_dwordx4 v[96:99], v12, s[16:19], s51 offen
    v_mfma_f32_16x16x32_bf16 v[220:223], v[116:119], a[44:47], v[220:223]
    buffer_load_dwordx4 v[100:103], v13, s[16:19], s51 offen
    v_mfma_f32_16x16x32_bf16 a[4:7], v[116:119], a[48:51], a[4:7]
    ds_read_b128 a[56:59], v4 offset:4096
    v_mfma_f32_16x16x32_bf16 v[128:131], v[112:115], a[32:35], v[128:131]
    v_perm_b32 v116, v21, v17, s43
    v_perm_b32 v117, v29, v25, s43
    v_mfma_f32_16x16x32_bf16 v[160:163], v[112:115], a[36:39], v[160:163]
    v_perm_b32 v118, v37, v33, s43
    v_perm_b32 v119, v45, v41, s43
    v_mfma_f32_16x16x32_bf16 v[192:195], v[112:115], a[40:43], v[192:195]
    buffer_load_dwordx4 v[104:107], v14, s[16:19], s51 offen
    v_mfma_f32_16x16x32_bf16 v[224:227], v[112:115], a[44:47], v[224:227]
    buffer_load_dwordx4 v[108:111], v15, s[16:19], s51 offen
    v_mfma_f32_16x16x32_bf16 a[8:11], v[112:115], a[48:51], a[8:11]
    ds_read_b128 a[60:63], v4 offset:8192
    v_mfma_f32_16x16x32_bf16 v[132:135], v[116:119], a[32:35], v[132:135]
    v_perm_b32 v112, v22, v18, s42
    v_perm_b32 v113, v30, v26, s42
    v_mfma_f32_16x16x32_bf16 v[164:167], v[116:119], a[36:39], v[164:167]
    v_perm_b32 v114, v38, v34, s42
    v_perm_b32 v115, v46, v42, s42
    v_mfma_f32_16x16x32_bf16 v[196:199], v[116:119], a[40:43], v[196:199]
    v_mfma_f32_16x16x32_bf16 v[228:231], v[116:119], a[44:47], v[228:231]
    v_mfma_f32_16x16x32_bf16 a[12:15], v[116:119], a[48:51], a[12:15]
    ds_read_b128 a[64:67], v4 offset:12288
    v_mfma_f32_16x16x32_bf16 v[136:139], v[112:115], a[32:35], v[136:139]
    v_perm_b32 v116, v22, v18, s43
    v_perm_b32 v117, v30, v26, s43
    v_mfma_f32_16x16x32_bf16 v[168:171], v[112:115], a[36:39], v[168:171]
    v_perm_b32 v118, v38, v34, s43
    v_perm_b32 v119, v46, v42, s43
    v_mfma_f32_16x16x32_bf16 v[200:203], v[112:115], a[40:43], v[200:203]
    v_mfma_f32_16x16x32_bf16 v[232:235], v[112:115], a[44:47], v[232:235]
    v_mfma_f32_16x16x32_bf16 a[16:19], v[112:115], a[48:51], a[16:19]
    ds_read_b128 a[68:71], v4 offset:16384
    v_mfma_f32_16x16x32_bf16 v[140:143], v[116:119], a[32:35], v[140:143]
    v_perm_b32 v112, v23, v19, s42
    v_perm_b32 v113, v31, v27, s42
    v_mfma_f32_16x16x32_bf16 v[172:175], v[116:119], a[36:39], v[172:175]
    v_perm_b32 v114, v39, v35, s42
    v_perm_b32 v115, v47, v43, s42
    v_mfma_f32_16x16x32_bf16 v[204:207], v[116:119], a[40:43], v[204:207]
    v_mfma_f32_16x16x32_bf16 v[236:239], v[116:119], a[44:47], v[236:239]
    v_mfma_f32_16x16x32_bf16 a[20:23], v[116:119], a[48:51], a[20:23]
    v_mfma_f32_16x16x32_bf16 v[144:147], v[112:115], a[32:35], v[144:147]
    v_perm_b32 v116, v23, v19, s43
    v_perm_b32 v117, v31, v27, s43
    v_mfma_f32_16x16x32_bf16 v[176:179], v[112:115], a[36:39], v[176:179]
    v_perm_b32 v118, v39, v35, s43
    v_perm_b32 v119, v47, v43, s43
    v_mfma_f32_16x16x32_bf16 v[208:211], v[112:115], a[40:43], v[208:211]
    v_mfma_f32_16x16x32_bf16 v[240:243], v[112:115], a[44:47], v[240:243]
    v_mfma_f32_16x16x32_bf16 a[24:27], v[112:115], a[48:51], a[24:27]
    v_mfma_f32_16x16x32_bf16 v[148:151], v[116:119], a[32:35], v[148:151]
    s_waitcnt vmcnt(8)
    s_nop 0
    v_perm_b32 v112, v52, v48, s42
    v_perm_b32 v113, v60, v56, s42
    v_mfma_f32_16x16x32_bf16 v[180:183], v[116:119], a[36:39], v[180:183]
    v_perm_b32 v114, v68, v64, s42
    v_perm_b32 v115, v76, v72, s42
    v_mfma_f32_16x16x32_bf16 v[212:215], v[116:119], a[40:43], v[212:215]
    s_xor_b32 s51, s52, 3932160
    buffer_load_dwordx4 v[16:19], v8, s[16:19], s51 offen
    v_mfma_f32_16x16x32_bf16 v[244:247], v[116:119], a[44:47], v[244:247]
    buffer_load_dwordx4 v[20:23], v9, s[16:19], s51 offen
    v_mfma_f32_16x16x32_bf16 a[28:31], v[116:119], a[48:51], a[28:31]
    s_waitcnt lgkmcnt(0)
    s_nop 0
    v_mfma_f32_16x16x32_bf16 v[120:123], v[112:115], a[52:55], v[120:123]
    v_perm_b32 v116, v52, v48, s43
    v_perm_b32 v117, v60, v56, s43
    v_mfma_f32_16x16x32_bf16 v[152:155], v[112:115], a[56:59], v[152:155]
    v_perm_b32 v118, v68, v64, s43
    v_perm_b32 v119, v76, v72, s43
    v_mfma_f32_16x16x32_bf16 v[184:187], v[112:115], a[60:63], v[184:187]
    buffer_load_dwordx4 v[24:27], v10, s[16:19], s51 offen
    v_mfma_f32_16x16x32_bf16 v[216:219], v[112:115], a[64:67], v[216:219]
    buffer_load_dwordx4 v[28:31], v11, s[16:19], s51 offen
    v_mfma_f32_16x16x32_bf16 a[0:3], v[112:115], a[68:71], a[0:3]
    v_xor_b32 v4, 61568, v3
    ds_read_b128 a[32:35], v4
    v_mfma_f32_16x16x32_bf16 v[124:127], v[116:119], a[52:55], v[124:127]
    v_perm_b32 v112, v53, v49, s42
    v_perm_b32 v113, v61, v57, s42
    v_mfma_f32_16x16x32_bf16 v[156:159], v[116:119], a[56:59], v[156:159]
    v_perm_b32 v114, v69, v65, s42
    v_perm_b32 v115, v77, v73, s42
    v_mfma_f32_16x16x32_bf16 v[188:191], v[116:119], a[60:63], v[188:191]
    buffer_load_dwordx4 v[32:35], v12, s[16:19], s51 offen
    v_mfma_f32_16x16x32_bf16 v[220:223], v[116:119], a[64:67], v[220:223]
    buffer_load_dwordx4 v[36:39], v13, s[16:19], s51 offen
    v_mfma_f32_16x16x32_bf16 a[4:7], v[116:119], a[68:71], a[4:7]
    ds_read_b128 a[36:39], v4 offset:4096
    v_mfma_f32_16x16x32_bf16 v[128:131], v[112:115], a[52:55], v[128:131]
    v_perm_b32 v116, v53, v49, s43
    v_perm_b32 v117, v61, v57, s43
    v_mfma_f32_16x16x32_bf16 v[160:163], v[112:115], a[56:59], v[160:163]
    v_perm_b32 v118, v69, v65, s43
    v_perm_b32 v119, v77, v73, s43
    v_mfma_f32_16x16x32_bf16 v[192:195], v[112:115], a[60:63], v[192:195]
    buffer_load_dwordx4 v[40:43], v14, s[16:19], s51 offen
    v_mfma_f32_16x16x32_bf16 v[224:227], v[112:115], a[64:67], v[224:227]
    buffer_load_dwordx4 v[44:47], v15, s[16:19], s51 offen
    v_mfma_f32_16x16x32_bf16 a[8:11], v[112:115], a[68:71], a[8:11]
    ds_read_b128 a[40:43], v4 offset:8192
    v_mfma_f32_16x16x32_bf16 v[132:135], v[116:119], a[52:55], v[132:135]
    v_perm_b32 v112, v54, v50, s42
    v_perm_b32 v113, v62, v58, s42
    v_mfma_f32_16x16x32_bf16 v[164:167], v[116:119], a[56:59], v[164:167]
    v_perm_b32 v114, v70, v66, s42
    v_perm_b32 v115, v78, v74, s42
    v_mfma_f32_16x16x32_bf16 v[196:199], v[116:119], a[60:63], v[196:199]
    v_mov_b32_e64 v5, 0
    v_mfma_f32_16x16x32_bf16 v[228:231], v[116:119], a[64:67], v[228:231]
    v_mfma_f32_16x16x32_bf16 a[12:15], v[116:119], a[68:71], a[12:15]
    ds_read_b128 a[44:47], v4 offset:12288
    v_mfma_f32_16x16x32_bf16 v[136:139], v[112:115], a[52:55], v[136:139]
    v_perm_b32 v116, v54, v50, s43
    v_perm_b32 v117, v62, v58, s43
    v_mfma_f32_16x16x32_bf16 v[168:171], v[112:115], a[56:59], v[168:171]
    v_perm_b32 v118, v70, v66, s43
    v_perm_b32 v119, v78, v74, s43
    v_mfma_f32_16x16x32_bf16 v[200:203], v[112:115], a[60:63], v[200:203]
    s_add_u32 s50, s45, 0
    s_add_u32 m0, s53, 0
    s_nop 0
    s_nop 0
    buffer_load_dwordx4 v6, s[12:15], s50 offen nt lds
    v_mfma_f32_16x16x32_bf16 v[232:235], v[112:115], a[64:67], v[232:235]
    buffer_load_dwordx4 v252, s[12:15], s50 offen offset:1024 nt lds
    v_mfma_f32_16x16x32_bf16 a[16:19], v[112:115], a[68:71], a[16:19]
    ds_read_b128 a[48:51], v4 offset:16384
    v_mfma_f32_16x16x32_bf16 v[140:143], v[116:119], a[52:55], v[140:143]
    v_perm_b32 v112, v55, v51, s42
    v_perm_b32 v113, v63, v59, s42
    v_mfma_f32_16x16x32_bf16 v[172:175], v[116:119], a[56:59], v[172:175]
    v_perm_b32 v114, v71, v67, s42
    v_perm_b32 v115, v79, v75, s42
    v_mfma_f32_16x16x32_bf16 v[204:207], v[116:119], a[60:63], v[204:207]
    buffer_load_dwordx4 v6, s[12:15], s50 offen offset:2048 nt lds
    v_mfma_f32_16x16x32_bf16 v[236:239], v[116:119], a[64:67], v[236:239]
    buffer_load_dwordx4 v252, s[12:15], s50 offen offset:3072 nt lds
    v_mfma_f32_16x16x32_bf16 a[20:23], v[116:119], a[68:71], a[20:23]
    v_mfma_f32_16x16x32_bf16 v[144:147], v[112:115], a[52:55], v[144:147]
    v_perm_b32 v116, v55, v51, s43
    v_perm_b32 v117, v63, v59, s43
    v_mfma_f32_16x16x32_bf16 v[176:179], v[112:115], a[56:59], v[176:179]
    v_perm_b32 v118, v71, v67, s43
    v_perm_b32 v119, v79, v75, s43
    v_mfma_f32_16x16x32_bf16 v[208:211], v[112:115], a[60:63], v[208:211]
    s_add_u32 s50, s45, 4096
    s_add_u32 m0, s53, 4096
    s_nop 0
    s_nop 0
    buffer_load_dwordx4 v6, s[12:15], s50 offen nt lds
    v_mfma_f32_16x16x32_bf16 v[240:243], v[112:115], a[64:67], v[240:243]
    buffer_load_dwordx4 v252, s[12:15], s50 offen offset:1024 nt lds
    v_mfma_f32_16x16x32_bf16 a[24:27], v[112:115], a[68:71], a[24:27]
    v_mfma_f32_16x16x32_bf16 v[148:151], v[116:119], a[52:55], v[148:151]
    s_waitcnt vmcnt(14)
    s_nop 0
    v_perm_b32 v48, v84, v80, s42
    v_perm_b32 v49, v92, v88, s42
    v_mfma_f32_16x16x32_bf16 v[180:183], v[116:119], a[56:59], v[180:183]
    v_perm_b32 v50, v100, v96, s42
    v_perm_b32 v51, v108, v104, s42
    v_mfma_f32_16x16x32_bf16 v[212:215], v[116:119], a[60:63], v[212:215]
    buffer_load_dwordx4 v6, s[12:15], s50 offen offset:2048 nt lds
    v_perm_b32 v52, v84, v80, s43
    v_perm_b32 v53, v92, v88, s43
    v_mfma_f32_16x16x32_bf16 v[244:247], v[116:119], a[64:67], v[244:247]
    buffer_load_dwordx4 v252, s[12:15], s50 offen offset:3072 nt lds
    v_perm_b32 v54, v100, v96, s43
    v_perm_b32 v55, v108, v104, s43
    v_mfma_f32_16x16x32_bf16 a[28:31], v[116:119], a[68:71], a[28:31]
    v_perm_b32 v56, v85, v81, s42
    v_perm_b32 v57, v93, v89, s42
    s_waitcnt lgkmcnt(0)
    s_nop 0
    v_mfma_f32_16x16x32_bf16 v[120:123], v[48:51], a[32:35], v[120:123]
    v_lshl_add_u32 v8, v254, 12, v255
    v_add_u32 v9, 16384, v8
    v_mfma_f32_16x16x32_bf16 v[124:127], v[52:55], a[32:35], v[124:127]
    v_xor_b32 v4, 61632, v3
    ds_read_b128 a[52:55], v4
    v_mfma_f32_16x16x32_bf16 v[152:155], v[48:51], a[36:39], v[152:155]
    v_perm_b32 v58, v101, v97, s42
    v_perm_b32 v59, v109, v105, s42
    v_mfma_f32_16x16x32_bf16 v[156:159], v[52:55], a[36:39], v[156:159]
    v_perm_b32 v60, v85, v81, s43
    v_perm_b32 v61, v93, v89, s43
    v_mfma_f32_16x16x32_bf16 v[128:131], v[56:59], a[32:35], v[128:131]
    v_perm_b32 v62, v101, v97, s43
    v_perm_b32 v63, v109, v105, s43
    v_mfma_f32_16x16x32_bf16 v[160:163], v[56:59], a[36:39], v[160:163]
    v_perm_b32 v64, v86, v82, s42
    v_perm_b32 v65, v94, v90, s42
    v_mfma_f32_16x16x32_bf16 v[132:135], v[60:63], a[32:35], v[132:135]
    s_add_u32 s50, s45, 8192
    v_perm_b32 v66, v102, v98, s42
    v_mfma_f32_16x16x32_bf16 v[164:167], v[60:63], a[36:39], v[164:167]
    v_perm_b32 v67, v110, v106, s42
    v_perm_b32 v68, v86, v82, s43
    v_mfma_f32_16x16x32_bf16 v[184:187], v[48:51], a[40:43], v[184:187]
    v_perm_b32 v69, v94, v90, s43
    v_perm_b32 v70, v102, v98, s43
    v_mfma_f32_16x16x32_bf16 v[136:139], v[64:67], a[32:35], v[136:139]
    v_perm_b32 v71, v110, v106, s43
    v_perm_b32 v72, v87, v83, s42
    v_mfma_f32_16x16x32_bf16 v[168:171], v[64:67], a[36:39], v[168:171]
    v_perm_b32 v73, v95, v91, s42
    v_perm_b32 v74, v103, v99, s42
    v_mfma_f32_16x16x32_bf16 v[140:143], v[68:71], a[32:35], v[140:143]
    v_perm_b32 v75, v111, v107, s42
    v_perm_b32 v76, v87, v83, s43
    v_mfma_f32_16x16x32_bf16 v[172:175], v[68:71], a[36:39], v[172:175]
    v_perm_b32 v77, v95, v91, s43
    v_perm_b32 v78, v103, v99, s43
    v_mfma_f32_16x16x32_bf16 v[144:147], v[72:75], a[32:35], v[144:147]
    s_add_u32 m0, s53, 8192
    v_perm_b32 v79, v111, v107, s43
    v_mfma_f32_16x16x32_bf16 v[176:179], v[72:75], a[36:39], v[176:179]
    s_waitcnt vmcnt(14)
    s_nop 0
    v_perm_b32 v80, v20, v16, s42
    s_waitcnt vmcnt(12)
    s_nop 0
    v_perm_b32 v81, v28, v24, s42
    v_mfma_f32_16x16x32_bf16 v[148:151], v[76:79], a[32:35], v[148:151]
    s_waitcnt vmcnt(10)
    s_nop 0
    v_perm_b32 v82, v36, v32, s42
    s_waitcnt vmcnt(8)
    s_nop 0
    v_perm_b32 v83, v44, v40, s42
    v_mfma_f32_16x16x32_bf16 v[180:183], v[76:79], a[36:39], v[180:183]
    v_perm_b32 v84, v20, v16, s43
    v_perm_b32 v85, v28, v24, s43
    s_waitcnt lgkmcnt(0)
    s_nop 0
    v_mfma_f32_16x16x32_bf16 v[120:123], v[80:83], a[52:55], v[120:123]
    v_perm_b32 v86, v36, v32, s43
    v_perm_b32 v87, v44, v40, s43
    v_mfma_f32_16x16x32_bf16 v[188:191], v[52:55], a[40:43], v[188:191]
    v_perm_b32 v88, v21, v17, s42
    v_perm_b32 v89, v29, v25, s42
    v_mfma_f32_16x16x32_bf16 v[124:127], v[84:87], a[52:55], v[124:127]
    v_perm_b32 v90, v37, v33, s42
    v_perm_b32 v91, v45, v41, s42
    v_mfma_f32_16x16x32_bf16 v[192:195], v[56:59], a[40:43], v[192:195]
    buffer_load_dwordx4 v6, s[12:15], s50 offen nt lds
    v_perm_b32 v92, v21, v17, s43
    v_mfma_f32_16x16x32_bf16 v[128:131], v[88:91], a[52:55], v[128:131]
    v_perm_b32 v93, v29, v25, s43
    v_perm_b32 v94, v37, v33, s43
    v_mfma_f32_16x16x32_bf16 v[196:199], v[60:63], a[40:43], v[196:199]
    v_perm_b32 v95, v45, v41, s43
    v_perm_b32 v96, v22, v18, s42
    v_mfma_f32_16x16x32_bf16 v[200:203], v[64:67], a[40:43], v[200:203]
    v_perm_b32 v97, v30, v26, s42
    v_perm_b32 v98, v38, v34, s42
    v_mfma_f32_16x16x32_bf16 v[132:135], v[92:95], a[52:55], v[132:135]
    v_perm_b32 v99, v46, v42, s42
    v_perm_b32 v100, v22, v18, s43
    v_mfma_f32_16x16x32_bf16 v[204:207], v[68:71], a[40:43], v[204:207]
    v_perm_b32 v101, v30, v26, s43
    v_perm_b32 v102, v38, v34, s43
    v_mfma_f32_16x16x32_bf16 v[136:139], v[96:99], a[52:55], v[136:139]
    v_perm_b32 v103, v46, v42, s43
    v_perm_b32 v104, v23, v19, s42
    v_mfma_f32_16x16x32_bf16 v[208:211], v[72:75], a[40:43], v[208:211]
    buffer_load_dwordx4 v252, s[12:15], s50 offen offset:1024 nt lds
    v_perm_b32 v105, v31, v27, s42
    v_mfma_f32_16x16x32_bf16 v[140:143], v[100:103], a[52:55], v[140:143]
    v_perm_b32 v106, v39, v35, s42
    v_perm_b32 v107, v47, v43, s42
    v_mfma_f32_16x16x32_bf16 v[212:215], v[76:79], a[40:43], v[212:215]
    v_perm_b32 v108, v23, v19, s43
    v_perm_b32 v109, v31, v27, s43
    v_mfma_f32_16x16x32_bf16 v[144:147], v[104:107], a[52:55], v[144:147]
    v_perm_b32 v110, v39, v35, s43
    v_perm_b32 v111, v47, v43, s43
    v_mfma_f32_16x16x32_bf16 v[216:219], v[48:51], a[44:47], v[216:219]
    v_cvt_pk_bf16_f32 v16, v120, v124
    v_cvt_pk_bf16_f32 v17, v128, v132
    v_mfma_f32_16x16x32_bf16 v[148:151], v[108:111], a[52:55], v[148:151]
    v_cvt_pk_bf16_f32 v18, v136, v140
    v_cvt_pk_bf16_f32 v20, v121, v125
    v_mfma_f32_16x16x32_bf16 v[220:223], v[52:55], a[44:47], v[220:223]
    v_cvt_pk_bf16_f32 v24, v122, v126
    buffer_load_dwordx4 v6, s[12:15], s50 offen offset:2048 nt lds
    v_mfma_f32_16x16x32_bf16 v[224:227], v[56:59], a[44:47], v[224:227]
    v_cvt_pk_bf16_f32 v28, v123, v127
    s_nop 0
    s_nop 0
    v_cvt_pk_bf16_f32 v19, v144, v148
    v_mfma_f32_16x16x32_bf16 v[228:231], v[60:63], a[44:47], v[228:231]
    v_cvt_pk_bf16_f32 v21, v129, v133
    v_cvt_pk_bf16_f32 v25, v130, v134
    v_mfma_f32_16x16x32_bf16 v[120:123], a[72:75], v[16:19], 0
    v_cvt_pk_bf16_f32 v29, v131, v135
    v_cvt_pk_bf16_f32 v22, v137, v141
    v_mfma_f32_16x16x32_bf16 v[124:127], a[88:91], v[16:19], 0
    v_cvt_pk_bf16_f32 v26, v138, v142
    v_cvt_pk_bf16_f32 v30, v139, v143
    v_mfma_f32_16x16x32_bf16 v[128:131], a[104:107], v[16:19], 0
    ds_read_b128 a[56:59], v4 offset:4096
    v_cvt_pk_bf16_f32 v23, v145, v149
    v_mfma_f32_16x16x32_bf16 v[132:135], a[120:123], v[16:19], 0
    v_cvt_pk_bf16_f32 v27, v146, v150
    v_cvt_pk_bf16_f32 v31, v147, v151
    v_mfma_f32_16x16x32_bf16 v[136:139], a[136:139], v[16:19], 0
    ds_read_b128 a[60:63], v4 offset:8192
    buffer_load_dwordx4 v252, s[12:15], s50 offen offset:3072 nt lds
    v_mfma_f32_16x16x32_bf16 v[120:123], a[76:79], v[20:23], v[120:123]
    ds_read_b128 a[64:67], v4 offset:12288
    ds_read_b128 a[68:71], v4 offset:16384
    v_mfma_f32_16x16x32_bf16 v[124:127], a[92:95], v[20:23], v[124:127]
    v_xor_b32 v10, 0, v7
    v_xor_b32 v11, 32, v7
    v_mfma_f32_16x16x32_bf16 v[128:131], a[108:111], v[20:23], v[128:131]
    v_mfma_f32_16x16x32_bf16 v[132:135], a[124:127], v[20:23], v[132:135]
    v_mfma_f32_16x16x32_bf16 v[136:139], a[140:143], v[20:23], v[136:139]
    v_mfma_f32_16x16x32_bf16 v[120:123], a[80:83], v[24:27], v[120:123]
    v_mfma_f32_16x16x32_bf16 v[124:127], a[96:99], v[24:27], v[124:127]
    s_add_u32 s50, s45, 12288
    v_mfma_f32_16x16x32_bf16 v[128:131], a[112:115], v[24:27], v[128:131]
    v_mfma_f32_16x16x32_bf16 v[132:135], a[128:131], v[24:27], v[132:135]
    v_mfma_f32_16x16x32_bf16 v[136:139], a[144:147], v[24:27], v[136:139]
    v_mfma_f32_16x16x32_bf16 v[120:123], a[84:87], v[28:31], v[120:123]
    v_mfma_f32_16x16x32_bf16 v[124:127], a[100:103], v[28:31], v[124:127]
    v_mfma_f32_16x16x32_bf16 v[128:131], a[116:119], v[28:31], v[128:131]
    s_nop 5
    s_nop 0
    v_max3_f32 v112, v120, v121, v122
    v_mfma_f32_16x16x32_bf16 v[132:135], a[132:135], v[28:31], v[132:135]
    s_add_u32 m0, s53, 12288
    v_max3_f32 v113, v123, v124, v125
    v_mfma_f32_16x16x32_bf16 v[136:139], a[148:151], v[28:31], v[136:139]
    v_max3_f32 v112, v112, v126, v127
    v_max3_f32 v113, v113, v128, v129
    s_waitcnt lgkmcnt(3)
    s_nop 0
    v_mfma_f32_16x16x32_bf16 v[152:155], v[80:83], a[56:59], v[152:155]
    v_max3_f32 v112, v112, v130, v131
    v_max3_f32 v113, v113, v132, v133
    v_mfma_f32_16x16x32_bf16 v[156:159], v[84:87], a[56:59], v[156:159]
    v_max3_f32 v112, v112, v134, v135
    v_max3_f32 v113, v113, v136, v137
    v_mfma_f32_16x16x32_bf16 v[160:163], v[88:91], a[56:59], v[160:163]
    v_max3_f32 v112, v112, v138, v139
    v_max_f32_e64 v112, v112, v113
    v_mfma_f32_16x16x32_bf16 v[164:167], v[92:95], a[56:59], v[164:167]
    v_mov_b32 v113, v112
    s_nop 0
    v_cvt_pk_bf16_f32 v32, v152, v156
    v_mfma_f32_16x16x32_bf16 v[168:171], v[96:99], a[56:59], v[168:171]
    v_cvt_pk_bf16_f32 v36, v153, v157
    v_cvt_pk_bf16_f32 v40, v154, v158
    v_mfma_f32_16x16x32_bf16 v[172:175], v[100:103], a[56:59], v[172:175]
    buffer_load_dwordx4 v6, s[12:15], s50 offen nt lds
    v_cvt_pk_bf16_f32 v33, v160, v164
    v_mfma_f32_16x16x32_bf16 v[176:179], v[104:107], a[56:59], v[176:179]
    v_cvt_pk_bf16_f32 v44, v155, v159
    v_permlane32_swap_b32 v112, v113
    s_nop 0
    v_mfma_f32_16x16x32_bf16 v[180:183], v[108:111], a[56:59], v[180:183]
    v_cvt_pk_bf16_f32 v37, v161, v165
    s_nop 0
    s_nop 0
    v_cvt_pk_bf16_f32 v34, v168, v172
    s_waitcnt lgkmcnt(2)
    s_nop 0
    v_mfma_f32_16x16x32_bf16 v[184:187], v[80:83], a[60:63], v[184:187]
    v_cvt_pk_bf16_f32 v41, v162, v166
    v_cvt_pk_bf16_f32 v45, v163, v167
    v_mfma_f32_16x16x32_bf16 v[188:191], v[84:87], a[60:63], v[188:191]
    v_max_f32_e64 v112, v112, v113
    v_cvt_pk_bf16_f32 v35, v176, v180
    v_mfma_f32_16x16x32_bf16 v[192:195], v[88:91], a[60:63], v[192:195]
    v_mov_b32_e64 v113, v112
    v_cvt_pk_bf16_f32 v38, v169, v173
    v_mfma_f32_16x16x32_bf16 v[152:155], a[72:75], v[32:35], 0
    v_cvt_pk_bf16_f32 v42, v170, v174
    v_cvt_pk_bf16_f32 v46, v171, v175
    v_mfma_f32_16x16x32_bf16 v[156:159], a[88:91], v[32:35], 0
    buffer_load_dwordx4 v252, s[12:15], s50 offen offset:1024 nt lds
    v_permlane16_swap_b32 v112, v113
    s_nop 0
    v_mfma_f32_16x16x32_bf16 v[160:163], a[104:107], v[32:35], 0
    v_max_f32 v112, v112, v113
    v_mul_f32 v112, s44, v112
    v_mfma_f32_16x16x32_bf16 v[164:167], a[120:123], v[32:35], 0
    v_cvt_pk_bf16_f32 v39, v177, v181
    v_fma_f32 v120, v120, s44, -v112
    v_mfma_f32_16x16x32_bf16 v[168:171], a[136:139], v[32:35], 0
    v_fma_f32 v121, v121, s44, -v112
    v_fma_f32 v122, v122, s44, -v112
    v_mfma_f32_16x16x32_bf16 v[152:155], a[76:79], v[36:39], v[152:155]
    v_fma_f32 v123, v123, s44, -v112
    v_fma_f32 v124, v124, s44, -v112
    v_mfma_f32_16x16x32_bf16 v[156:159], a[92:95], v[36:39], v[156:159]
    v_fma_f32 v125, v125, s44, -v112
    v_exp_f32_e64 v120, v120
    v_mfma_f32_16x16x32_bf16 v[160:163], a[108:111], v[36:39], v[160:163]
    v_exp_f32_e64 v121, v121
    v_mfma_f32_16x16x32_bf16 v[164:167], a[124:127], v[36:39], v[164:167]
    buffer_load_dwordx4 v6, s[12:15], s50 offen offset:2048 nt lds
    v_exp_f32_e64 v122, v122
    v_mfma_f32_16x16x32_bf16 v[168:171], a[140:143], v[36:39], v[168:171]
    v_exp_f32_e64 v123, v123
    v_mfma_f32_16x16x32_bf16 v[196:199], v[92:95], a[60:63], v[196:199]
    v_fma_f32 v126, v126, s44, -v112
    v_fma_f32 v127, v127, s44, -v112
    v_mfma_f32_16x16x32_bf16 v[200:203], v[96:99], a[60:63], v[200:203]
    v_exp_f32_e64 v124, v124
    v_mfma_f32_16x16x32_bf16 v[204:207], v[100:103], a[60:63], v[204:207]
    v_exp_f32_e64 v125, v125
    v_mfma_f32_16x16x32_bf16 v[208:211], v[104:107], a[60:63], v[208:211]
    v_fma_f32 v128, v128, s44, -v112
    v_fma_f32 v129, v129, s44, -v112
    v_mfma_f32_16x16x32_bf16 v[212:215], v[108:111], a[60:63], v[212:215]
    buffer_load_dwordx4 v252, s[12:15], s50 offen offset:3072 nt lds
    v_exp_f32_e64 v126, v126
    v_mfma_f32_16x16x32_bf16 v[232:235], v[64:67], a[44:47], v[232:235]
    v_exp_f32_e64 v127, v127
    v_mfma_f32_16x16x32_bf16 v[236:239], v[68:71], a[44:47], v[236:239]
    v_fma_f32 v130, v130, s44, -v112
    v_fma_f32 v131, v131, s44, -v112
    v_mfma_f32_16x16x32_bf16 v[240:243], v[72:75], a[44:47], v[240:243]
    v_exp_f32_e64 v128, v128
    v_mfma_f32_16x16x32_bf16 v[244:247], v[76:79], a[44:47], v[244:247]
    v_exp_f32 v129, v129
    s_waitcnt lgkmcnt(1)
    v_mfma_f32_16x16x32_bf16 v[216:219], v[80:83], a[64:67], v[216:219]
    v_add_f32 v114, v120, v121
    v_add_f32 v115, v122, v123
    v_mfma_f32_16x16x32_bf16 v[220:223], v[84:87], a[64:67], v[220:223]
    v_fma_f32 v132, v132, s44, -v112
    v_fma_f32 v133, v133, s44, -v112
    v_mfma_f32_16x16x32_bf16 v[224:227], v[88:91], a[64:67], v[224:227]
    s_add_u32 s50, s45, 16384
    v_exp_f32_e64 v130, v130
    v_mfma_f32_16x16x32_bf16 v[228:231], v[92:95], a[64:67], v[228:231]
    v_exp_f32_e64 v131, v131
    v_mfma_f32_16x16x32_bf16 v[232:235], v[96:99], a[64:67], v[232:235]
    v_add_f32 v114, v114, v124
    v_add_f32 v115, v115, v125
    v_mfma_f32_16x16x32_bf16 v[236:239], v[100:103], a[64:67], v[236:239]
    v_fma_f32 v134, v134, s44, -v112
    v_fma_f32 v135, v135, s44, -v112
    v_mfma_f32_16x16x32_bf16 v[240:243], v[104:107], a[64:67], v[240:243]
    v_exp_f32_e64 v132, v132
    v_mfma_f32_16x16x32_bf16 v[244:247], v[108:111], a[64:67], v[244:247]
    v_exp_f32_e64 v133, v133
    v_mfma_f32_16x16x32_bf16 a[0:3], v[48:51], a[48:51], a[0:3]
    v_add_f32_e64 v114, v114, v126
    s_add_u32 m0, s53, 16384
    v_mfma_f32_16x16x32_bf16 a[4:7], v[52:55], a[48:51], a[4:7]
    s_lshl_b32 s52, s38, 19
    s_lshl_b32 s47, s39, 8
    v_mfma_f32_16x16x32_bf16 a[8:11], v[56:59], a[48:51], a[8:11]
    s_add_u32 s52, s52, s47
    s_lshl_b32 s47, s41, 15
    v_mfma_f32_16x16x32_bf16 a[12:15], v[60:63], a[48:51], a[12:15]
    s_add_u32 s52, s52, s47
    s_lshr_b32 s47, s41, 2
    v_mfma_f32_16x16x32_bf16 a[16:19], v[64:67], a[48:51], a[16:19]
    s_xor_b32 s47, s47, s39
    s_nop 0
    s_mul_i32 s47, s47, 20480
    v_mfma_f32_16x16x32_bf16 a[20:23], v[68:71], a[48:51], a[20:23]
    v_add_u32 v248, s47, v2
    v_xor_b32 v249, 64, v248
    v_mfma_f32_16x16x32_bf16 a[24:27], v[72:75], a[48:51], a[24:27]
    v_xor_b32 v250, 128, v248
    v_xor_b32 v251, 192, v248
    v_mfma_f32_16x16x32_bf16 a[28:31], v[76:79], a[48:51], a[28:31]
    buffer_load_dwordx4 v6, s[12:15], s50 offen nt lds
    v_add_f32 v115, v115, v127
    s_waitcnt lgkmcnt(0)
    v_mfma_f32_16x16x32_bf16 a[0:3], v[80:83], a[68:71], a[0:3]
    v_fma_f32 v136, v136, s44, -v112
    v_fma_f32 v137, v137, s44, -v112
    v_mfma_f32_16x16x32_bf16 a[4:7], v[84:87], a[68:71], a[4:7]
    v_exp_f32_e64 v134, v134
    v_mfma_f32_16x16x32_bf16 a[8:11], v[88:91], a[68:71], a[8:11]
    v_exp_f32_e64 v135, v135
    v_mfma_f32_16x16x32_bf16 a[12:15], v[92:95], a[68:71], a[12:15]
    v_add_f32 v114, v114, v128
    v_add_f32 v115, v115, v129
    v_mfma_f32_16x16x32_bf16 a[16:19], v[96:99], a[68:71], a[16:19]
    v_fma_f32 v138, v138, s44, -v112
    v_fma_f32 v139, v139, s44, -v112
    v_mfma_f32_16x16x32_bf16 a[20:23], v[100:103], a[68:71], a[20:23]
    v_exp_f32_e64 v136, v136
    v_mfma_f32_16x16x32_bf16 a[24:27], v[104:107], a[68:71], a[24:27]
    buffer_load_dwordx4 v252, s[12:15], s50 offen offset:1024 nt lds
    v_exp_f32_e64 v137, v137
    v_mfma_f32_16x16x32_bf16 a[28:31], v[108:111], a[68:71], a[28:31]
    v_add_f32 v114, v114, v130
    v_add_f32 v115, v115, v131
    v_exp_f32 v138, v138
    v_exp_f32 v139, v139
    v_add_f32 v114, v114, v132
    v_add_f32 v115, v115, v133
    v_add_f32 v114, v114, v134
    v_add_f32 v115, v115, v135
    v_cvt_pk_bf16_f32 v43, v178, v182
    v_add_f32 v114, v114, v136
    v_add_f32 v115, v115, v137
    v_mfma_f32_16x16x32_bf16 v[152:155], a[80:83], v[40:43], v[152:155]
    v_add_f32 v114, v114, v138
    v_add_f32 v115, v115, v139
    v_mfma_f32_16x16x32_bf16 v[156:159], a[96:99], v[40:43], v[156:159]
    v_add_f32 v114, v114, v115
    v_mov_b32 v115, v114
    v_mfma_f32_16x16x32_bf16 v[160:163], a[112:115], v[40:43], v[160:163]
    buffer_load_dwordx4 v6, s[12:15], s50 offen offset:2048 nt lds
    v_permlane32_swap_b32 v114, v115
    s_nop 0
    v_mfma_f32_16x16x32_bf16 v[164:167], a[128:131], v[40:43], v[164:167]
    v_add_f32 v114, v114, v115
    v_mov_b32 v115, v114
    v_mfma_f32_16x16x32_bf16 v[168:171], a[144:147], v[40:43], v[168:171]
    v_cvt_pk_bf16_f32 v47, v179, v183
    v_permlane16_swap_b32 v114, v115
    v_add_f32 v114, v114, v115
    v_mfma_f32_16x16x32_bf16 v[152:155], a[84:87], v[44:47], v[152:155]
    v_rcp_f32_e64 v114, v114
    v_mfma_f32_16x16x32_bf16 v[156:159], a[100:103], v[44:47], v[156:159]
    v_cvt_pk_bf16_f32 v16, v184, v188
    v_cvt_pk_bf16_f32 v17, v192, v196
    v_mfma_f32_16x16x32_bf16 v[160:163], a[116:119], v[44:47], v[160:163]
    v_cvt_pk_bf16_f32 v18, v200, v204
    v_cvt_pk_bf16_f32 v19, v208, v212
    v_mfma_f32_16x16x32_bf16 v[164:167], a[132:135], v[44:47], v[164:167]
    v_mul_f32 v120, v120, v114
    v_mul_f32 v121, v121, v114
    v_mfma_f32_16x16x32_bf16 v[168:171], a[148:151], v[44:47], v[168:171]
    buffer_load_dwordx4 v252, s[12:15], s50 offen offset:3072 nt lds
    v_mul_f32 v122, v122, v114
    v_mul_f32 v123, v123, v114
    v_mul_f32 v124, v124, v114
    v_mul_f32 v125, v125, v114
    v_mul_f32 v126, v126, v114
    v_mul_f32 v127, v127, v114
    v_cvt_pk_bf16_f32 v140, v120, v121
    v_cvt_pk_bf16_f32 v141, v122, v123
    v_mfma_f32_16x16x32_bf16 v[120:123], a[72:75], v[16:19], 0
    v_mul_f32 v128, v128, v114
    v_mul_f32 v129, v129, v114
    v_mul_f32 v130, v130, v114
    v_mul_f32 v131, v131, v114
    v_cvt_pk_bf16_f32 v142, v124, v125
    v_cvt_pk_bf16_f32 v143, v126, v127
    v_mfma_f32_16x16x32_bf16 v[124:127], a[88:91], v[16:19], 0
    v_mul_f32 v132, v132, v114
    v_mul_f32 v133, v133, v114
    v_mul_f32 v134, v134, v114
    v_mul_f32 v135, v135, v114
    v_cvt_pk_bf16_f32 v144, v128, v129
    v_cvt_pk_bf16_f32 v145, v130, v131
    v_mfma_f32_16x16x32_bf16 v[128:131], a[104:107], v[16:19], 0
    v_mul_f32 v136, v136, v114
    v_mul_f32 v137, v137, v114
    v_mul_f32 v138, v138, v114
    v_mul_f32 v139, v139, v114
    v_cvt_pk_bf16_f32 v146, v132, v133
    v_cvt_pk_bf16_f32 v147, v134, v135
    v_mfma_f32_16x16x32_bf16 v[132:135], a[120:123], v[16:19], 0
    v_cvt_pk_bf16_f32 v148, v136, v137
    v_cvt_pk_bf16_f32 v149, v138, v139
    v_mfma_f32_16x16x32_bf16 v[136:139], a[136:139], v[16:19], 0
    v_max3_f32 v116, v152, v153, v154
    v_cvt_pk_bf16_f32 v20, v185, v189
    v_cvt_pk_bf16_f32 v21, v193, v197
    v_cvt_pk_bf16_f32 v22, v201, v205
    v_cvt_pk_bf16_f32 v23, v209, v213
    v_max3_f32 v117, v155, v156, v157
    v_max3_f32 v116, v116, v158, v159
    v_mfma_f32_16x16x32_bf16 v[120:123], a[76:79], v[20:23], v[120:123]
    v_max3_f32 v117, v117, v160, v161
    v_max3_f32 v116, v116, v162, v163
    v_mfma_f32_16x16x32_bf16 v[124:127], a[92:95], v[20:23], v[124:127]
    v_max3_f32 v117, v117, v164, v165
    v_max3_f32 v116, v116, v166, v167
    v_mfma_f32_16x16x32_bf16 v[128:131], a[108:111], v[20:23], v[128:131]
    v_max3_f32 v117, v117, v168, v169
    v_max3_f32 v116, v116, v170, v171
    v_mfma_f32_16x16x32_bf16 v[132:135], a[124:127], v[20:23], v[132:135]
    v_max_f32 v116, v116, v117
    v_mov_b32 v117, v116
    v_mfma_f32_16x16x32_bf16 v[136:139], a[140:143], v[20:23], v[136:139]
    s_nop 0
    v_permlane32_swap_b32 v116, v117
    v_max_f32 v116, v116, v117
    v_mov_b32 v117, v116
    v_cvt_pk_bf16_f32 v24, v186, v190
    v_cvt_pk_bf16_f32 v25, v194, v198
    v_cvt_pk_bf16_f32 v26, v202, v206
    v_cvt_pk_bf16_f32 v27, v210, v214
    v_permlane16_swap_b32 v116, v117
    v_max_f32 v116, v116, v117
    v_mfma_f32_16x16x32_bf16 v[120:123], a[80:83], v[24:27], v[120:123]
    v_mul_f32_e64 v116, s44, v116
    v_fma_f32 v152, v152, s44, -v116
    v_mfma_f32_16x16x32_bf16 v[124:127], a[96:99], v[24:27], v[124:127]
    v_fma_f32 v153, v153, s44, -v116
    v_fma_f32 v154, v154, s44, -v116
    v_mfma_f32_16x16x32_bf16 v[128:131], a[112:115], v[24:27], v[128:131]
    v_fma_f32 v155, v155, s44, -v116
    v_fma_f32 v156, v156, s44, -v116
    v_mfma_f32_16x16x32_bf16 v[132:135], a[128:131], v[24:27], v[132:135]
    v_fma_f32 v157, v157, s44, -v116
    v_exp_f32_e64 v152, v152
    v_mfma_f32_16x16x32_bf16 v[136:139], a[144:147], v[24:27], v[136:139]
    v_exp_f32 v153, v153
    v_exp_f32 v154, v154
    v_exp_f32_e64 v155, v155
    v_fma_f32 v158, v158, s44, -v116
    v_fma_f32 v159, v159, s44, -v116
    v_exp_f32 v156, v156
    v_exp_f32 v157, v157
    v_fma_f32 v160, v160, s44, -v116
    v_fma_f32 v161, v161, s44, -v116
    v_exp_f32 v158, v158
    v_exp_f32 v159, v159
    v_fma_f32 v162, v162, s44, -v116
    v_fma_f32 v163, v163, s44, -v116
    v_exp_f32 v160, v160
    v_exp_f32 v161, v161
    v_add_f32 v118, v152, v153
    v_add_f32 v119, v154, v155
    v_fma_f32 v164, v164, s44, -v116
    v_fma_f32 v165, v165, s44, -v116
    v_exp_f32 v162, v162
    v_exp_f32 v163, v163
    v_add_f32 v118, v118, v156
    v_add_f32 v119, v119, v157
    v_cvt_pk_bf16_f32 v28, v187, v191
    v_cvt_pk_bf16_f32 v29, v195, v199
    v_cvt_pk_bf16_f32 v30, v203, v207
    v_cvt_pk_bf16_f32 v31, v211, v215
    s_barrier
    s_nop 0
    v_mfma_f32_16x16x32_bf16 v[120:123], a[84:87], v[28:31], v[120:123]
    v_fma_f32 v166, v166, s44, -v116
    v_fma_f32 v167, v167, s44, -v116
    v_mfma_f32_16x16x32_bf16 v[124:127], a[100:103], v[28:31], v[124:127]
    v_exp_f32_e64 v164, v164
    v_mfma_f32_16x16x32_bf16 v[128:131], a[116:119], v[28:31], v[128:131]
    v_exp_f32_e64 v165, v165
    v_mfma_f32_16x16x32_bf16 v[132:135], a[132:135], v[28:31], v[132:135]
    v_add_f32 v118, v118, v158
    v_add_f32 v119, v119, v159
    v_mfma_f32_16x16x32_bf16 v[136:139], a[148:151], v[28:31], v[136:139]
    v_fma_f32 v168, v168, s44, -v116
    v_fma_f32 v169, v169, s44, -v116
    v_exp_f32 v166, v166
    v_exp_f32 v167, v167
    v_add_f32 v118, v118, v160
    v_add_f32 v119, v119, v161
    v_fma_f32 v170, v170, s44, -v116
    v_fma_f32 v171, v171, s44, -v116
    v_exp_f32 v168, v168
    v_exp_f32 v169, v169
    v_add_f32 v118, v118, v162
    v_add_f32 v119, v119, v163
    v_cvt_pk_bf16_f32 v32, v216, v220
    v_cvt_pk_bf16_f32 v36, v217, v221
    v_cvt_pk_bf16_f32 v40, v218, v222
    v_cvt_pk_bf16_f32 v44, v219, v223
    v_exp_f32 v170, v170
    v_exp_f32 v171, v171
    v_add_f32 v118, v118, v164
    v_add_f32 v119, v119, v165
    v_cvt_pk_bf16_f32 v33, v224, v228
    v_cvt_pk_bf16_f32 v37, v225, v229
    v_cvt_pk_bf16_f32 v41, v226, v230
    v_cvt_pk_bf16_f32 v45, v227, v231
    v_add_f32 v118, v118, v166
    v_add_f32 v119, v119, v167
    v_cvt_pk_bf16_f32 v34, v232, v236
    v_cvt_pk_bf16_f32 v38, v233, v237
    v_cvt_pk_bf16_f32 v42, v234, v238
    v_cvt_pk_bf16_f32 v46, v235, v239
    v_add_f32 v118, v118, v168
    v_add_f32 v119, v119, v169
    v_cvt_pk_bf16_f32 v35, v240, v244
    v_cvt_pk_bf16_f32 v39, v241, v245
    v_cvt_pk_bf16_f32 v43, v242, v246
    v_cvt_pk_bf16_f32 v47, v243, v247
    v_add_f32 v118, v118, v170
    v_add_f32 v119, v119, v171
    v_add_f32 v118, v118, v119
    v_mov_b32 v119, v118
    v_max3_f32 v112, v120, v121, v122
    v_max3_f32 v113, v123, v124, v125
    v_permlane32_swap_b32 v118, v119
    v_add_f32 v118, v118, v119
    v_mov_b32_e64 v119, v118
    v_max3_f32 v112, v112, v126, v127
    v_max3_f32 v113, v113, v128, v129
    v_permlane16_swap_b32 v118, v119
    s_nop 0
    v_max3_f32 v112, v112, v130, v131
    v_add_f32_e64 v118, v118, v119
    v_max3_f32 v113, v113, v132, v133
    v_max3_f32 v112, v112, v134, v135
    v_rcp_f32_e64 v118, v118
    v_max3_f32 v113, v113, v136, v137
    v_max3_f32 v112, v112, v138, v139
    v_max_f32 v112, v112, v113
    v_mov_b32 v113, v112
    v_mul_f32 v152, v152, v118
    v_mul_f32 v153, v153, v118
    v_mul_f32 v154, v154, v118
    v_mul_f32 v155, v155, v118
    v_mul_f32 v156, v156, v118
    v_mul_f32 v157, v157, v118
    v_mul_f32 v158, v158, v118
    v_mul_f32 v159, v159, v118
    v_cvt_pk_bf16_f32 v172, v152, v153
    v_cvt_pk_bf16_f32 v173, v154, v155
    v_mfma_f32_16x16x32_bf16 v[152:155], a[72:75], v[32:35], 0
    v_mul_f32 v160, v160, v118
    v_mul_f32 v161, v161, v118
    v_mul_f32 v162, v162, v118
    v_mul_f32 v163, v163, v118
    v_cvt_pk_bf16_f32 v174, v156, v157
    v_cvt_pk_bf16_f32 v175, v158, v159
    v_mfma_f32_16x16x32_bf16 v[156:159], a[88:91], v[32:35], 0
    v_permlane32_swap_b32 v112, v113
    v_mul_f32 v164, v164, v118
    v_mfma_f32_16x16x32_bf16 v[152:155], a[76:79], v[36:39], v[152:155]
    v_mul_f32 v165, v165, v118
    v_mul_f32 v166, v166, v118
    v_mul_f32_e64 v167, v167, v118
    v_cvt_pk_bf16_f32 v176, v160, v161
    v_cvt_pk_bf16_f32 v177, v162, v163
    v_mfma_f32_16x16x32_bf16 v[160:163], a[104:107], v[32:35], 0
    v_max_f32 v112, v112, v113
    v_mul_f32 v168, v168, v118
    v_mfma_f32_16x16x32_bf16 v[156:159], a[92:95], v[36:39], v[156:159]
    v_mul_f32 v169, v169, v118
    v_mul_f32 v170, v170, v118
    v_mfma_f32_16x16x32_bf16 v[152:155], a[80:83], v[40:43], v[152:155]
    v_mul_f32_e64 v171, v171, v118
    v_cvt_pk_bf16_f32 v178, v164, v165
    v_mfma_f32_16x16x32_bf16 v[160:163], a[108:111], v[36:39], v[160:163]
    v_cvt_pk_bf16_f32 v179, v166, v167
    v_mov_b32_e64 v113, v112
    v_mfma_f32_16x16x32_bf16 v[164:167], a[120:123], v[32:35], 0
    v_cvt_pk_bf16_f32 v180, v168, v169
    v_cvt_pk_bf16_f32 v181, v170, v171
    v_mfma_f32_16x16x32_bf16 v[168:171], a[136:139], v[32:35], 0
    v_permlane16_swap_b32 v112, v113
    v_max_f32 v112, v112, v113
    v_mfma_f32_16x16x32_bf16 v[156:159], a[96:99], v[40:43], v[156:159]
    v_mul_f32_e64 v112, s44, v112
    v_fma_f32 v120, v120, s44, -v112
    v_mfma_f32_16x16x32_bf16 v[164:167], a[124:127], v[36:39], v[164:167]
    v_fma_f32 v121, v121, s44, -v112
    v_fma_f32 v122, v122, s44, -v112
    v_mfma_f32_16x16x32_bf16 v[168:171], a[140:143], v[36:39], v[168:171]
    v_fma_f32 v123, v123, s44, -v112
    v_fma_f32 v124, v124, s44, -v112
    v_mfma_f32_16x16x32_bf16 v[160:163], a[112:115], v[40:43], v[160:163]
    v_fma_f32 v125, v125, s44, -v112
    v_exp_f32_e64 v120, v120
    v_mfma_f32_16x16x32_bf16 v[164:167], a[128:131], v[40:43], v[164:167]
    v_exp_f32_e64 v121, v121
    v_mfma_f32_16x16x32_bf16 v[168:171], a[144:147], v[40:43], v[168:171]
    v_exp_f32_e64 v122, v122
    v_mfma_f32_16x16x32_bf16 v[152:155], a[84:87], v[44:47], v[152:155]
    v_exp_f32_e64 v123, v123
    v_mfma_f32_16x16x32_bf16 v[156:159], a[100:103], v[44:47], v[156:159]
    v_fma_f32 v126, v126, s44, -v112
    v_fma_f32 v127, v127, s44, -v112
    v_mfma_f32_16x16x32_bf16 v[160:163], a[116:119], v[44:47], v[160:163]
    v_exp_f32_e64 v124, v124
    v_mfma_f32_16x16x32_bf16 v[164:167], a[132:135], v[44:47], v[164:167]
    v_exp_f32_e64 v125, v125
    v_mfma_f32_16x16x32_bf16 v[168:171], a[148:151], v[44:47], v[168:171]
    v_fma_f32 v128, v128, s44, -v112
    v_fma_f32 v129, v129, s44, -v112
    v_exp_f32 v126, v126
    v_exp_f32 v127, v127
    v_fma_f32 v130, v130, s44, -v112
    v_fma_f32 v131, v131, s44, -v112
    v_exp_f32 v128, v128
    v_exp_f32 v129, v129
    v_add_f32 v114, v120, v121
    v_add_f32 v115, v122, v123
    v_fma_f32 v132, v132, s44, -v112
    v_fma_f32 v133, v133, s44, -v112
    v_exp_f32 v130, v130
    v_exp_f32 v131, v131
    v_add_f32 v114, v114, v124
    v_add_f32 v115, v115, v125
    v_fma_f32 v134, v134, s44, -v112
    v_fma_f32 v135, v135, s44, -v112
    v_exp_f32 v132, v132
    v_exp_f32 v133, v133
    v_add_f32 v114, v114, v126
    v_add_f32 v115, v115, v127
    v_fma_f32 v136, v136, s44, -v112
    v_fma_f32 v137, v137, s44, -v112
    v_exp_f32 v134, v134
    v_exp_f32 v135, v135
    v_add_f32 v114, v114, v128
    v_add_f32 v115, v115, v129
    v_fma_f32 v138, v138, s44, -v112
    v_fma_f32 v139, v139, s44, -v112
    v_exp_f32 v136, v136
    v_exp_f32 v137, v137
    v_add_f32 v114, v114, v130
    v_add_f32 v115, v115, v131
    v_exp_f32 v138, v138
    v_exp_f32 v139, v139
    v_add_f32 v114, v114, v132
    v_add_f32 v115, v115, v133
    v_add_f32 v114, v114, v134
    v_add_f32 v115, v115, v135
    v_add_f32 v114, v114, v136
    v_add_f32 v115, v115, v137
    v_add_f32 v114, v114, v138
    v_add_f32 v115, v115, v139
    v_add_f32 v114, v114, v115
    v_mov_b32 v115, v114
    v_accvgpr_read_b32 v12, a0
    v_accvgpr_read_b32 v13, a4
    v_permlane32_swap_b32 v114, v115
    v_add_f32 v114, v114, v115
    v_mov_b32_e64 v115, v114
    v_accvgpr_read_b32 v14, a8
    v_accvgpr_read_b32 v15, a12
    v_permlane16_swap_b32 v114, v115
    v_add_f32 v114, v114, v115
    v_cvt_pk_bf16_f32 v16, v12, v13
    v_cvt_pk_bf16_f32 v17, v14, v15
    v_rcp_f32_e64 v114, v114
    v_accvgpr_read_b32 v12, a16
    v_accvgpr_read_b32 v13, a20
    v_accvgpr_read_b32 v14, a24
    v_accvgpr_read_b32 v15, a28
    v_cvt_pk_bf16_f32 v18, v12, v13
    v_cvt_pk_bf16_f32 v19, v14, v15
    v_mul_f32 v120, v120, v114
    v_mul_f32 v121, v121, v114
    v_mul_f32 v122, v122, v114
    v_mul_f32 v123, v123, v114
    v_mul_f32 v124, v124, v114
    v_mul_f32 v125, v125, v114
    v_mul_f32 v126, v126, v114
    v_mul_f32 v127, v127, v114
    v_cvt_pk_bf16_f32 v184, v120, v121
    v_cvt_pk_bf16_f32 v185, v122, v123
    v_mfma_f32_16x16x32_bf16 v[120:123], a[72:75], v[16:19], 0
    v_mul_f32 v128, v128, v114
    v_mul_f32 v129, v129, v114
    v_mul_f32_e64 v130, v130, v114
    v_mul_f32 v131, v131, v114
    s_xor_b32 s51, s52, 0
    v_cvt_pk_bf16_f32 v186, v124, v125
    v_cvt_pk_bf16_f32 v187, v126, v127
    v_mfma_f32_16x16x32_bf16 v[124:127], a[88:91], v[16:19], 0
    v_mul_f32 v132, v132, v114
    v_mul_f32 v133, v133, v114
    v_mul_f32 v134, v134, v114
    v_mul_f32 v135, v135, v114
    v_cvt_pk_bf16_f32 v188, v128, v129
    buffer_load_dwordx4 v[48:51], v8, s[20:23], s51 offen
    v_cvt_pk_bf16_f32 v189, v130, v131
    v_mfma_f32_16x16x32_bf16 v[128:131], a[104:107], v[16:19], 0
    v_mul_f32 v136, v136, v114
    v_mul_f32 v137, v137, v114
    v_mul_f32 v138, v138, v114
    v_mul_f32 v139, v139, v114
    v_cvt_pk_bf16_f32 v190, v132, v133
    v_cvt_pk_bf16_f32 v191, v134, v135
    v_mfma_f32_16x16x32_bf16 v[132:135], a[120:123], v[16:19], 0
    buffer_load_dwordx4 v[52:55], v8, s[20:23], s51 offen offset:1024
    v_cvt_pk_bf16_f32 v192, v136, v137
    v_cvt_pk_bf16_f32 v193, v138, v139
    v_mfma_f32_16x16x32_bf16 v[136:139], a[136:139], v[16:19], 0
    v_accvgpr_read_b32 v12, a1
    v_accvgpr_read_b32 v13, a5
    v_accvgpr_read_b32 v14, a9
    buffer_load_dwordx4 v[56:59], v8, s[20:23], s51 offen offset:2048
    v_accvgpr_read_b32 v15, a13
    v_cvt_pk_bf16_f32 v20, v12, v13
    v_cvt_pk_bf16_f32 v21, v14, v15
    v_accvgpr_read_b32 v12, a17
    v_accvgpr_read_b32 v13, a21
    v_accvgpr_read_b32 v14, a25
    v_accvgpr_read_b32 v15, a29
    v_max3_f32 v116, v152, v153, v154
    v_cvt_pk_bf16_f32 v22, v12, v13
    buffer_load_dwordx4 v[60:63], v8, s[20:23], s51 offen offset:3072
    v_cvt_pk_bf16_f32 v23, v14, v15
    v_max3_f32 v117, v155, v156, v157
    v_max3_f32 v116, v116, v158, v159
    v_mfma_f32_16x16x32_bf16 v[120:123], a[76:79], v[20:23], v[120:123]
    v_max3_f32 v117, v117, v160, v161
    v_max3_f32 v116, v116, v162, v163
    v_mfma_f32_16x16x32_bf16 v[124:127], a[92:95], v[20:23], v[124:127]
    buffer_load_dwordx4 v[64:67], v9, s[20:23], s51 offen
    v_max3_f32 v117, v117, v164, v165
    v_mfma_f32_16x16x32_bf16 v[128:131], a[108:111], v[20:23], v[128:131]
    v_max3_f32 v116, v116, v166, v167
    v_max3_f32 v117, v117, v168, v169
    v_mfma_f32_16x16x32_bf16 v[132:135], a[124:127], v[20:23], v[132:135]
    v_max3_f32 v116, v116, v170, v171
    v_max_f32_e64 v116, v116, v117
    v_mfma_f32_16x16x32_bf16 v[136:139], a[140:143], v[20:23], v[136:139]
    buffer_load_dwordx4 v[68:71], v9, s[20:23], s51 offen offset:1024
    v_mov_b32_e64 v117, v116
    v_accvgpr_read_b32 v12, a2
    v_accvgpr_read_b32 v13, a6
    v_accvgpr_read_b32 v14, a10
    v_accvgpr_read_b32 v15, a14
    v_permlane32_swap_b32 v116, v117
    s_nop 0
    v_cvt_pk_bf16_f32 v24, v12, v13
    buffer_load_dwordx4 v[72:75], v9, s[20:23], s51 offen offset:2048
    v_cvt_pk_bf16_f32 v25, v14, v15
    v_max_f32_e64 v116, v116, v117
    v_accvgpr_read_b32 v12, a18
    v_accvgpr_read_b32 v13, a22
    v_accvgpr_read_b32 v14, a26
    v_accvgpr_read_b32 v15, a30
    v_mov_b32_e64 v117, v116
    v_cvt_pk_bf16_f32 v26, v12, v13
    v_cvt_pk_bf16_f32 v27, v14, v15
    buffer_load_dwordx4 v[76:79], v9, s[20:23], s51 offen offset:3072
    v_permlane16_swap_b32 v116, v117
    s_nop 0
    v_mfma_f32_16x16x32_bf16 v[120:123], a[80:83], v[24:27], v[120:123]
    v_max_f32 v116, v116, v117
    v_mul_f32 v116, s44, v116
    v_mfma_f32_16x16x32_bf16 v[124:127], a[96:99], v[24:27], v[124:127]
    v_fma_f32 v152, v152, s44, -v116
    v_fma_f32 v153, v153, s44, -v116
    v_mfma_f32_16x16x32_bf16 v[128:131], a[112:115], v[24:27], v[128:131]
    v_fma_f32 v154, v154, s44, -v116
    v_fma_f32 v155, v155, s44, -v116
    v_mfma_f32_16x16x32_bf16 v[132:135], a[128:131], v[24:27], v[132:135]
    v_fma_f32 v156, v156, s44, -v116
    v_fma_f32 v157, v157, s44, -v116
    v_mfma_f32_16x16x32_bf16 v[136:139], a[144:147], v[24:27], v[136:139]
    v_exp_f32 v152, v152
    v_exp_f32 v153, v153
    v_exp_f32 v154, v154
    v_exp_f32 v155, v155
    v_fma_f32 v158, v158, s44, -v116
    v_fma_f32 v159, v159, s44, -v116
    v_exp_f32 v156, v156
    v_exp_f32 v157, v157
    v_accvgpr_read_b32 v12, a3
    v_accvgpr_read_b32 v13, a7
    v_accvgpr_read_b32 v14, a11
    v_accvgpr_read_b32 v15, a15
    v_fma_f32 v160, v160, s44, -v116
    v_fma_f32 v161, v161, s44, -v116
    v_exp_f32 v158, v158
    v_exp_f32 v159, v159
    v_cvt_pk_bf16_f32 v28, v12, v13
    v_cvt_pk_bf16_f32 v29, v14, v15
    v_fma_f32 v162, v162, s44, -v116
    v_fma_f32 v163, v163, s44, -v116
    v_exp_f32 v160, v160
    v_exp_f32 v161, v161
    v_add_f32 v118, v152, v153
    v_add_f32 v119, v154, v155
    v_accvgpr_read_b32 v12, a19
    v_accvgpr_read_b32 v13, a23
    v_accvgpr_read_b32 v14, a27
    v_accvgpr_read_b32 v15, a31
    v_fma_f32 v164, v164, s44, -v116
    v_fma_f32 v165, v165, s44, -v116
    v_exp_f32 v162, v162
    v_exp_f32 v163, v163
    v_add_f32 v118, v118, v156
    v_add_f32 v119, v119, v157
    v_cvt_pk_bf16_f32 v30, v12, v13
    v_cvt_pk_bf16_f32 v31, v14, v15
    v_fma_f32 v166, v166, s44, -v116
    v_fma_f32 v167, v167, s44, -v116
    v_mfma_f32_16x16x32_bf16 v[120:123], a[84:87], v[28:31], v[120:123]
    v_exp_f32_e64 v164, v164
    v_mfma_f32_16x16x32_bf16 v[124:127], a[100:103], v[28:31], v[124:127]
    v_exp_f32_e64 v165, v165
    v_mfma_f32_16x16x32_bf16 v[128:131], a[116:119], v[28:31], v[128:131]
    v_add_f32 v118, v118, v158
    v_add_f32 v119, v119, v159
    v_mfma_f32_16x16x32_bf16 v[132:135], a[132:135], v[28:31], v[132:135]
    v_fma_f32 v168, v168, s44, -v116
    v_fma_f32 v169, v169, s44, -v116
    v_mfma_f32_16x16x32_bf16 v[136:139], a[148:151], v[28:31], v[136:139]
    v_exp_f32 v166, v166
    v_exp_f32 v167, v167
    v_add_f32 v118, v118, v160
    v_add_f32 v119, v119, v161
    v_fma_f32 v170, v170, s44, -v116
    v_fma_f32 v171, v171, s44, -v116
    v_exp_f32 v168, v168
    v_exp_f32 v169, v169
    v_add_f32 v118, v118, v162
    v_add_f32 v119, v119, v163
    v_exp_f32 v170, v170
    v_exp_f32 v171, v171
    v_add_f32 v118, v118, v164
    v_add_f32 v119, v119, v165
    v_add_f32 v118, v118, v166
    v_add_f32 v119, v119, v167
    v_add_f32 v118, v118, v168
    v_add_f32 v119, v119, v169
    v_add_f32 v118, v118, v170
    v_add_f32 v119, v119, v171
    v_add_f32 v118, v118, v119
    v_mov_b32 v119, v118
    v_max3_f32 v112, v120, v121, v122
    v_max3_f32 v113, v123, v124, v125
    v_permlane32_swap_b32 v118, v119
    v_add_f32 v118, v118, v119
    s_waitcnt vmcnt(8)
    s_nop 0
    ds_read_b64_tr_b16 a[152:153], v10
    ds_read_b64_tr_b16 a[154:155], v10 offset:4096
    ds_read_b64_tr_b16 a[156:157], v10 offset:8192
    ds_read_b64_tr_b16 a[158:159], v10 offset:12288
    ds_read_b64_tr_b16 a[160:161], v10 offset:16384
    ds_read_b64_tr_b16 a[162:163], v11
    ds_read_b64_tr_b16 a[164:165], v11 offset:4096
    ds_read_b64_tr_b16 a[166:167], v11 offset:8192
    ds_read_b64_tr_b16 a[168:169], v11 offset:12288
    ds_read_b64_tr_b16 a[170:171], v11 offset:16384
    v_xor_b32_e64 v10, 64, v7
    ds_read_b64_tr_b16 a[172:173], v10
    ds_read_b64_tr_b16 a[174:175], v10 offset:4096
    ds_read_b64_tr_b16 a[176:177], v10 offset:8192
    ds_read_b64_tr_b16 a[178:179], v10 offset:12288
    ds_read_b64_tr_b16 a[180:181], v10 offset:16384
    v_xor_b32 v11, 96, v7
    ds_read_b64_tr_b16 a[182:183], v11
    ds_read_b64_tr_b16 a[184:185], v11 offset:4096
    ds_read_b64_tr_b16 a[186:187], v11 offset:8192
    ds_read_b64_tr_b16 a[188:189], v11 offset:12288
    ds_read_b64_tr_b16 a[190:191], v11 offset:16384
    v_xor_b32 v10, 128, v7
    ds_read_b64_tr_b16 a[192:193], v10
    ds_read_b64_tr_b16 a[194:195], v10 offset:4096
    ds_read_b64_tr_b16 a[196:197], v10 offset:8192
    ds_read_b64_tr_b16 a[198:199], v10 offset:12288
    ds_read_b64_tr_b16 a[200:201], v10 offset:16384
    v_xor_b32 v11, 160, v7
    ds_read_b64_tr_b16 a[202:203], v11
    ds_read_b64_tr_b16 a[204:205], v11 offset:4096
    ds_read_b64_tr_b16 a[206:207], v11 offset:8192
    ds_read_b64_tr_b16 a[208:209], v11 offset:12288
    ds_read_b64_tr_b16 a[210:211], v11 offset:16384
    s_waitcnt lgkmcnt(15)
    s_nop 0
    v_mfma_f32_16x16x32_bf16 v[216:219], a[152:155], v[140:143], 0
    v_xor_b32 v10, 192, v7
    ds_read_b64_tr_b16 a[212:213], v10
    ds_read_b64_tr_b16 a[214:215], v10 offset:4096
    v_mfma_f32_16x16x32_bf16 v[220:223], a[162:165], v[140:143], 0
    ds_read_b64_tr_b16 a[216:217], v10 offset:8192
    ds_read_b64_tr_b16 a[218:219], v10 offset:12288
    ds_read_b64_tr_b16 a[220:221], v10 offset:16384
    v_xor_b32 v11, 224, v7
    v_mfma_f32_16x16x32_bf16 v[224:227], a[172:175], v[140:143], 0
    ds_read_b64_tr_b16 a[222:223], v11
    ds_read_b64_tr_b16 a[224:225], v11 offset:4096
    v_mfma_f32_16x16x32_bf16 v[216:219], a[156:159], v[144:147], v[216:219]
    ds_read_b64_tr_b16 a[226:227], v11 offset:8192
    ds_read_b64_tr_b16 a[228:229], v11 offset:12288
    s_waitcnt lgkmcnt(15)
    s_nop 0
    v_mfma_f32_16x16x32_bf16 v[228:231], a[182:185], v[140:143], 0
    ds_read_b64_tr_b16 a[230:231], v11 offset:16384
    v_mov_b32_e64 v119, v118
    v_mfma_f32_16x16x32_bf16 v[232:235], a[192:195], v[140:143], 0
    v_max3_f32 v112, v112, v126, v127
    v_permlane16_swap_b32 v118, v119
    s_nop 0
    v_mfma_f32_16x16x32_bf16 v[224:227], a[176:179], v[144:147], v[224:227]
    v_max3_f32 v113, v113, v128, v129
    v_max3_f32 v112, v112, v130, v131
    s_waitcnt lgkmcnt(13)
    s_nop 0
    v_mfma_f32_16x16x32_bf16 v[236:239], a[202:205], v[140:143], 0
    v_add_f32_e64 v118, v118, v119
    v_max3_f32 v113, v113, v132, v133
    v_mfma_f32_16x16x32_bf16 v[220:223], a[166:169], v[144:147], v[220:223]
    v_max3_f32 v112, v112, v134, v135
    v_rcp_f32 v118, v118
    s_waitcnt lgkmcnt(8)
    v_mfma_f32_16x16x32_bf16 v[240:243], a[212:215], v[140:143], 0
    v_max3_f32 v113, v113, v136, v137
    v_max3_f32 v112, v112, v138, v139
    v_mfma_f32_16x16x32_bf16 v[232:235], a[196:199], v[144:147], v[232:235]
    v_max_f32_e64 v112, v112, v113
    v_mov_b32 v113, v112
    s_waitcnt lgkmcnt(3)
    v_mfma_f32_16x16x32_bf16 v[244:247], a[222:225], v[140:143], 0
    v_mul_f32 v152, v152, v118
    v_mul_f32 v153, v153, v118
    v_mfma_f32_16x16x32_bf16 v[228:231], a[186:189], v[144:147], v[228:231]
    v_mul_f32 v154, v154, v118
    v_mul_f32 v155, v155, v118
    v_mfma_f32_16x16x32_bf16 v[240:243], a[216:219], v[144:147], v[240:243]
    v_mul_f32 v156, v156, v118
    v_mul_f32 v157, v157, v118
    v_mfma_f32_16x16x32_bf16 v[236:239], a[206:209], v[144:147], v[236:239]
    v_mul_f32_e64 v158, v158, v118
    v_mul_f32 v159, v159, v118
    s_waitcnt lgkmcnt(1)
    v_mfma_f32_16x16x32_bf16 v[244:247], a[226:229], v[144:147], v[244:247]
    v_cvt_pk_bf16_f32 v194, v152, v153
    v_cvt_pk_bf16_f32 v195, v154, v155
    v_mfma_f32_16x16x16_bf16 v[216:219], a[160:161], v[148:149], v[216:219]
    v_cvt_pk_bf16_f32 v196, v156, v157
    v_cvt_pk_bf16_f32 v197, v158, v159
    v_mfma_f32_16x16x16_bf16 v[224:227], a[180:181], v[148:149], v[224:227]
    v_permlane32_swap_b32 v112, v113
    v_max_f32 v112, v112, v113
    v_mfma_f32_16x16x16_bf16 v[220:223], a[170:171], v[148:149], v[220:223]
    v_mov_b32 v113, v112
    s_nop 0
    v_cvt_pk_bf16_f32 v216, v216, v217
    v_mfma_f32_16x16x16_bf16 v[232:235], a[200:201], v[148:149], v[232:235]
    v_cvt_pk_bf16_f32 v217, v218, v219
    v_cvt_pk_bf16_f32 v224, v224, v225
    v_mfma_f32_16x16x16_bf16 v[228:231], a[190:191], v[148:149], v[228:231]
    v_cvt_pk_bf16_f32 v225, v226, v227
    v_cvt_pk_bf16_f32 v218, v220, v221
    v_mfma_f32_16x16x16_bf16 v[240:243], a[220:221], v[148:149], v[240:243]
    v_cvt_pk_bf16_f32 v219, v222, v223
    s_nop 0
    s_nop 0
    v_cvt_pk_bf16_f32 v232, v232, v233
    v_mfma_f32_16x16x16_bf16 v[236:239], a[210:211], v[148:149], v[236:239]
    ds_write_b128 v248, v[216:219]
    v_cvt_pk_bf16_f32 v226, v228, v229
    s_waitcnt lgkmcnt(1)
    s_nop 0
    v_mfma_f32_16x16x16_bf16 v[244:247], a[230:231], v[148:149], v[244:247]
    v_cvt_pk_bf16_f32 v227, v230, v231
    v_cvt_pk_bf16_f32 v233, v234, v235
    v_mfma_f32_16x16x32_bf16 v[216:219], a[152:155], v[172:175], 0
    v_cvt_pk_bf16_f32 v240, v240, v241
    v_cvt_pk_bf16_f32 v234, v236, v237
    v_mfma_f32_16x16x32_bf16 v[220:223], a[162:165], v[172:175], 0
    v_cvt_pk_bf16_f32 v235, v238, v239
    v_cvt_pk_bf16_f32 v241, v242, v243
    v_mfma_f32_16x16x32_bf16 v[228:231], a[182:185], v[172:175], 0
    ds_write_b128 v249, v[224:227]
    v_cvt_pk_bf16_f32 v242, v244, v245
    v_mfma_f32_16x16x32_bf16 v[224:227], a[172:175], v[172:175], 0
    v_cvt_pk_bf16_f32 v243, v246, v247
    v_permlane16_swap_b32 v112, v113
    s_nop 0
    v_mfma_f32_16x16x32_bf16 v[236:239], a[202:205], v[172:175], 0
    v_max_f32 v112, v112, v113
    v_mul_f32 v112, s44, v112
    v_mfma_f32_16x16x32_bf16 v[244:247], a[222:225], v[172:175], 0
    v_fma_f32 v120, v120, s44, -v112
    v_fma_f32 v121, v121, s44, -v112
    v_mfma_f32_16x16x32_bf16 v[216:219], a[156:159], v[176:179], v[216:219]
    ds_write_b128 v250, v[232:235]
    v_fma_f32 v122, v122, s44, -v112
    v_mfma_f32_16x16x32_bf16 v[232:235], a[192:195], v[172:175], 0
    v_fma_f32 v123, v123, s44, -v112
    v_mul_f32_e64 v160, v160, v118
    v_mfma_f32_16x16x32_bf16 v[224:227], a[176:179], v[176:179], v[224:227]
    v_mul_f32 v161, v161, v118
    v_mul_f32 v162, v162, v118
    v_mfma_f32_16x16x32_bf16 v[220:223], a[166:169], v[176:179], v[220:223]
    v_mul_f32 v163, v163, v118
    v_mul_f32 v164, v164, v118
    v_mfma_f32_16x16x32_bf16 v[232:235], a[196:199], v[176:179], v[232:235]
    ds_write_b128 v251, v[240:243]
    v_mul_f32_e64 v165, v165, v118
    v_mfma_f32_16x16x32_bf16 v[240:243], a[212:215], v[172:175], 0
    v_mul_f32 v166, v166, v118
    v_mul_f32 v167, v167, v118
    v_mfma_f32_16x16x32_bf16 v[228:231], a[186:189], v[176:179], v[228:231]
    v_fma_f32 v124, v124, s44, -v112
    v_fma_f32 v125, v125, s44, -v112
    v_mfma_f32_16x16x32_bf16 v[236:239], a[206:209], v[176:179], v[236:239]
    v_exp_f32_e64 v120, v120
    v_mfma_f32_16x16x32_bf16 v[240:243], a[216:219], v[176:179], v[240:243]
    v_exp_f32_e64 v121, v121
    v_mfma_f32_16x16x32_bf16 v[244:247], a[226:229], v[176:179], v[244:247]
    v_exp_f32_e64 v122, v122
    v_mfma_f32_16x16x16_bf16 v[216:219], a[160:161], v[180:181], v[216:219]
    v_exp_f32_e64 v123, v123
    v_mfma_f32_16x16x16_bf16 v[224:227], a[180:181], v[180:181], v[224:227]
    v_cvt_pk_bf16_f32 v198, v160, v161
    v_cvt_pk_bf16_f32 v199, v162, v163
    v_mfma_f32_16x16x16_bf16 v[220:223], a[170:171], v[180:181], v[220:223]
    v_cvt_pk_bf16_f32 v200, v164, v165
    s_nop 1
    s_nop 0
    v_cvt_pk_bf16_f32 v216, v216, v217
    v_mfma_f32_16x16x16_bf16 v[232:235], a[200:201], v[180:181], v[232:235]
    v_cvt_pk_bf16_f32 v217, v218, v219
    v_cvt_pk_bf16_f32 v224, v224, v225
    v_mfma_f32_16x16x16_bf16 v[228:231], a[190:191], v[180:181], v[228:231]
    v_cvt_pk_bf16_f32 v225, v226, v227
    v_cvt_pk_bf16_f32 v218, v220, v221
    v_mfma_f32_16x16x16_bf16 v[240:243], a[220:221], v[180:181], v[240:243]
    v_cvt_pk_bf16_f32 v219, v222, v223
    s_nop 0
    s_nop 0
    v_cvt_pk_bf16_f32 v232, v232, v233
    v_mfma_f32_16x16x16_bf16 v[236:239], a[210:211], v[180:181], v[236:239]
    ds_write_b128 v248, v[216:219] offset:4096
    v_cvt_pk_bf16_f32 v226, v228, v229
    v_mfma_f32_16x16x16_bf16 v[244:247], a[230:231], v[180:181], v[244:247]
    v_cvt_pk_bf16_f32 v227, v230, v231
    v_cvt_pk_bf16_f32 v233, v234, v235
    v_mfma_f32_16x16x32_bf16 v[216:219], a[152:155], v[184:187], 0
    v_cvt_pk_bf16_f32 v240, v240, v241
    s_nop 0
    s_nop 0
    v_cvt_pk_bf16_f32 v234, v236, v237
    v_mfma_f32_16x16x32_bf16 v[220:223], a[162:165], v[184:187], 0
    v_cvt_pk_bf16_f32 v235, v238, v239
    v_cvt_pk_bf16_f32 v241, v242, v243
    v_mfma_f32_16x16x32_bf16 v[228:231], a[182:185], v[184:187], 0
    ds_write_b128 v249, v[224:227] offset:4096
    v_cvt_pk_bf16_f32 v242, v244, v245
    v_mfma_f32_16x16x32_bf16 v[224:227], a[172:175], v[184:187], 0
    v_cvt_pk_bf16_f32 v243, v246, v247
    v_cvt_pk_bf16_f32 v201, v166, v167
    v_mfma_f32_16x16x32_bf16 v[236:239], a[202:205], v[184:187], 0
    v_fma_f32 v126, v126, s44, -v112
    v_fma_f32 v127, v127, s44, -v112
    v_mfma_f32_16x16x32_bf16 v[244:247], a[222:225], v[184:187], 0
    v_exp_f32_e64 v124, v124
    v_mfma_f32_16x16x32_bf16 v[216:219], a[156:159], v[188:191], v[216:219]
    ds_write_b128 v250, v[232:235] offset:4096
    v_exp_f32_e64 v125, v125
    v_mfma_f32_16x16x32_bf16 v[232:235], a[192:195], v[184:187], 0
    v_fma_f32 v128, v128, s44, -v112
    v_fma_f32 v129, v129, s44, -v112
    v_mfma_f32_16x16x32_bf16 v[224:227], a[176:179], v[188:191], v[224:227]
    v_exp_f32_e64 v126, v126
    v_mfma_f32_16x16x32_bf16 v[220:223], a[166:169], v[188:191], v[220:223]
    v_exp_f32_e64 v127, v127
    v_mfma_f32_16x16x32_bf16 v[232:235], a[196:199], v[188:191], v[232:235]
    ds_write_b128 v251, v[240:243] offset:4096
    v_fma_f32 v130, v130, s44, -v112
    v_mfma_f32_16x16x32_bf16 v[240:243], a[212:215], v[184:187], 0
    v_fma_f32 v131, v131, s44, -v112
    v_exp_f32_e64 v128, v128
    v_mfma_f32_16x16x32_bf16 v[228:231], a[186:189], v[188:191], v[228:231]
    v_exp_f32_e64 v129, v129
    v_mfma_f32_16x16x32_bf16 v[236:239], a[206:209], v[188:191], v[236:239]
    v_add_f32 v114, v120, v121
    v_add_f32 v115, v122, v123
    v_mfma_f32_16x16x32_bf16 v[240:243], a[216:219], v[188:191], v[240:243]
    v_fma_f32 v132, v132, s44, -v112
    v_fma_f32 v133, v133, s44, -v112
    v_mfma_f32_16x16x32_bf16 v[244:247], a[226:229], v[188:191], v[244:247]
    v_exp_f32_e64 v130, v130
    v_mfma_f32_16x16x16_bf16 v[216:219], a[160:161], v[192:193], v[216:219]
    v_exp_f32_e64 v131, v131
    v_mfma_f32_16x16x16_bf16 v[224:227], a[180:181], v[192:193], v[224:227]
    v_add_f32 v114, v114, v124
    v_add_f32 v115, v115, v125
    v_mfma_f32_16x16x16_bf16 v[220:223], a[170:171], v[192:193], v[220:223]
    v_fma_f32 v134, v134, s44, -v112
    s_nop 1
    s_nop 0
    v_cvt_pk_bf16_f32 v216, v216, v217
    v_mfma_f32_16x16x16_bf16 v[232:235], a[200:201], v[192:193], v[232:235]
    v_cvt_pk_bf16_f32 v217, v218, v219
    v_cvt_pk_bf16_f32 v224, v224, v225
    v_mfma_f32_16x16x16_bf16 v[228:231], a[190:191], v[192:193], v[228:231]
    v_cvt_pk_bf16_f32 v225, v226, v227
    v_cvt_pk_bf16_f32 v218, v220, v221
    v_mfma_f32_16x16x16_bf16 v[240:243], a[220:221], v[192:193], v[240:243]
    v_cvt_pk_bf16_f32 v219, v222, v223
    s_nop 0
    s_nop 0
    v_cvt_pk_bf16_f32 v232, v232, v233
    v_mfma_f32_16x16x16_bf16 v[236:239], a[210:211], v[192:193], v[236:239]
    ds_write_b128 v248, v[216:219] offset:8192
    v_cvt_pk_bf16_f32 v226, v228, v229
    v_mfma_f32_16x16x16_bf16 v[244:247], a[230:231], v[192:193], v[244:247]
    v_cvt_pk_bf16_f32 v227, v230, v231
    v_cvt_pk_bf16_f32 v233, v234, v235
    v_mfma_f32_16x16x32_bf16 v[216:219], a[152:155], v[194:197], 0
    v_cvt_pk_bf16_f32 v240, v240, v241
    s_nop 0
    s_nop 0
    v_cvt_pk_bf16_f32 v234, v236, v237
    v_mfma_f32_16x16x32_bf16 v[220:223], a[162:165], v[194:197], 0
    v_cvt_pk_bf16_f32 v235, v238, v239
    v_cvt_pk_bf16_f32 v241, v242, v243
    v_mfma_f32_16x16x32_bf16 v[228:231], a[182:185], v[194:197], 0
    ds_write_b128 v249, v[224:227] offset:8192
    v_cvt_pk_bf16_f32 v242, v244, v245
    v_mfma_f32_16x16x32_bf16 v[224:227], a[172:175], v[194:197], 0
    v_cvt_pk_bf16_f32 v243, v246, v247
    v_fma_f32 v135, v135, s44, -v112
    v_mfma_f32_16x16x32_bf16 v[236:239], a[202:205], v[194:197], 0
    v_exp_f32_e64 v132, v132
    v_mfma_f32_16x16x32_bf16 v[244:247], a[222:225], v[194:197], 0
    s_xor_b32 s51, s52, 32768
    v_exp_f32_e64 v133, v133
    v_mfma_f32_16x16x32_bf16 v[216:219], a[156:159], v[198:201], v[216:219]
    ds_write_b128 v250, v[232:235] offset:8192
    v_add_f32_e64 v114, v114, v126
    v_mfma_f32_16x16x32_bf16 v[232:235], a[192:195], v[194:197], 0
    buffer_load_dwordx4 v[80:83], v8, s[20:23], s51 offen
    v_add_f32_e64 v115, v115, v127
    v_mfma_f32_16x16x32_bf16 v[224:227], a[176:179], v[198:201], v[224:227]
    v_fma_f32 v136, v136, s44, -v112
    v_fma_f32 v137, v137, s44, -v112
    v_mfma_f32_16x16x32_bf16 v[220:223], a[166:169], v[198:201], v[220:223]
    v_exp_f32_e64 v134, v134
    v_mfma_f32_16x16x32_bf16 v[232:235], a[196:199], v[198:201], v[232:235]
    buffer_load_dwordx4 v[84:87], v8, s[20:23], s51 offen offset:1024
    ds_write_b128 v251, v[240:243] offset:8192
    v_mfma_f32_16x16x32_bf16 v[240:243], a[212:215], v[194:197], 0
    v_exp_f32_e64 v135, v135
    v_mfma_f32_16x16x32_bf16 v[228:231], a[186:189], v[198:201], v[228:231]
    buffer_load_dwordx4 v[88:91], v8, s[20:23], s51 offen offset:2048
    v_add_f32_e64 v114, v114, v128
    v_mfma_f32_16x16x32_bf16 v[236:239], a[206:209], v[198:201], v[236:239]
    v_add_f32_e64 v115, v115, v129
    v_fma_f32 v138, v138, s44, -v112
    v_mfma_f32_16x16x32_bf16 v[240:243], a[216:219], v[198:201], v[240:243]
    v_fma_f32 v139, v139, s44, -v112
    v_exp_f32_e64 v136, v136
    v_mfma_f32_16x16x32_bf16 v[244:247], a[226:229], v[198:201], v[244:247]
    buffer_load_dwordx4 v[92:95], v8, s[20:23], s51 offen offset:3072
    v_exp_f32 v137, v137
    v_add_f32 v114, v114, v130
    v_add_f32 v115, v115, v131
    v_exp_f32 v138, v138
    buffer_load_dwordx4 v[96:99], v9, s[20:23], s51 offen
    v_exp_f32 v139, v139
    v_add_f32 v114, v114, v132
    v_add_f32 v115, v115, v133
    v_add_f32 v114, v114, v134
    v_add_f32 v115, v115, v135
    v_add_f32 v114, v114, v136
    v_add_f32 v115, v115, v137
    v_mul_f32 v168, v168, v118
    buffer_load_dwordx4 v[100:103], v9, s[20:23], s51 offen offset:1024
    v_mul_f32 v169, v169, v118
    v_mul_f32 v170, v170, v118
    v_mul_f32 v171, v171, v118
    v_add_f32 v114, v114, v138
    v_add_f32_e64 v115, v115, v139
    v_cvt_pk_bf16_f32 v202, v168, v169
    v_cvt_pk_bf16_f32 v203, v170, v171
    v_add_f32 v114, v114, v115
    v_mov_b32 v115, v114
    v_mfma_f32_16x16x16_bf16 v[216:219], a[160:161], v[202:203], v[216:219]
    buffer_load_dwordx4 v[104:107], v9, s[20:23], s51 offen offset:2048
    v_permlane32_swap_b32 v114, v115
    s_nop 0
    v_mfma_f32_16x16x16_bf16 v[224:227], a[180:181], v[202:203], v[224:227]
    v_add_f32 v114, v114, v115
    v_mov_b32 v115, v114
    v_mfma_f32_16x16x16_bf16 v[220:223], a[170:171], v[202:203], v[220:223]
    buffer_load_dwordx4 v[108:111], v9, s[20:23], s51 offen offset:3072
    v_permlane16_swap_b32 v114, v115
    s_nop 0
    v_mfma_f32_16x16x16_bf16 v[232:235], a[200:201], v[202:203], v[232:235]
    v_add_f32 v114, v114, v115
    v_rcp_f32 v114, v114
    v_mfma_f32_16x16x16_bf16 v[228:231], a[190:191], v[202:203], v[228:231]
    v_mul_f32 v120, v120, v114
    v_mul_f32 v121, v121, v114
    v_mfma_f32_16x16x16_bf16 v[240:243], a[220:221], v[202:203], v[240:243]
    v_mul_f32 v122, v122, v114
    v_mul_f32 v123, v123, v114
    v_mfma_f32_16x16x16_bf16 v[236:239], a[210:211], v[202:203], v[236:239]
    v_mul_f32 v124, v124, v114
    v_mul_f32 v125, v125, v114
    v_mfma_f32_16x16x16_bf16 v[244:247], a[230:231], v[202:203], v[244:247]
    v_mul_f32 v126, v126, v114
    v_mul_f32 v127, v127, v114
    v_cvt_pk_bf16_f32 v216, v216, v217
    v_cvt_pk_bf16_f32 v204, v120, v121
    v_cvt_pk_bf16_f32 v205, v122, v123
    v_cvt_pk_bf16_f32 v206, v124, v125
    v_cvt_pk_bf16_f32 v207, v126, v127
    v_cvt_pk_bf16_f32 v217, v218, v219
    v_cvt_pk_bf16_f32 v224, v224, v225
    v_cvt_pk_bf16_f32 v218, v220, v221
    v_cvt_pk_bf16_f32 v219, v222, v223
    v_mfma_f32_16x16x32_bf16 v[220:223], a[162:165], v[204:207], 0
    v_cvt_pk_bf16_f32 v225, v226, v227
    v_cvt_pk_bf16_f32 v232, v232, v233
    ds_write_b128 v248, v[216:219] offset:12288
    v_mfma_f32_16x16x32_bf16 v[216:219], a[152:155], v[204:207], 0
    v_cvt_pk_bf16_f32 v226, v228, v229
    v_cvt_pk_bf16_f32 v227, v230, v231
    v_mfma_f32_16x16x32_bf16 v[228:231], a[182:185], v[204:207], 0
    v_cvt_pk_bf16_f32 v233, v234, v235
    v_cvt_pk_bf16_f32 v240, v240, v241
    s_xor_b32 s51, s52, 65536
    v_cvt_pk_bf16_f32 v234, v236, v237
    v_cvt_pk_bf16_f32 v235, v238, v239
    v_mfma_f32_16x16x32_bf16 v[236:239], a[202:205], v[204:207], 0
    v_cvt_pk_bf16_f32 v241, v242, v243
    v_cvt_pk_bf16_f32 v242, v244, v245
    ds_write_b128 v249, v[224:227] offset:12288
    v_mfma_f32_16x16x32_bf16 v[224:227], a[172:175], v[204:207], 0
    buffer_load_dwordx4 v[16:19], v8, s[20:23], s51 offen
    v_cvt_pk_bf16_f32 v243, v246, v247
    v_mfma_f32_16x16x32_bf16 v[244:247], a[222:225], v[204:207], 0
    v_mul_f32 v128, v128, v114
    v_mul_f32 v129, v129, v114
    v_mul_f32 v130, v130, v114
    v_mul_f32 v131, v131, v114
    v_mul_f32 v132, v132, v114
    v_mul_f32 v133, v133, v114
    buffer_load_dwordx4 v[20:23], v8, s[20:23], s51 offen offset:1024
    v_mul_f32 v134, v134, v114
    v_mul_f32 v135, v135, v114
    ds_write_b128 v250, v[232:235] offset:12288
    v_mfma_f32_16x16x32_bf16 v[232:235], a[192:195], v[204:207], 0
    v_cvt_pk_bf16_f32 v208, v128, v129
    v_cvt_pk_bf16_f32 v209, v130, v131
    v_cvt_pk_bf16_f32 v210, v132, v133
    v_cvt_pk_bf16_f32 v211, v134, v135
    buffer_load_dwordx4 v[24:27], v8, s[20:23], s51 offen offset:2048
    v_mul_f32_e64 v136, v136, v114
    v_mfma_f32_16x16x32_bf16 v[216:219], a[156:159], v[208:211], v[216:219]
    v_mul_f32 v137, v137, v114
    v_mul_f32 v138, v138, v114
    v_mfma_f32_16x16x32_bf16 v[224:227], a[176:179], v[208:211], v[224:227]
    v_mul_f32_e64 v139, v139, v114
    ds_write_b128 v251, v[240:243] offset:12288
    v_mfma_f32_16x16x32_bf16 v[240:243], a[212:215], v[204:207], 0
    buffer_load_dwordx4 v[28:31], v8, s[20:23], s51 offen offset:3072
    v_cvt_pk_bf16_f32 v212, v136, v137
    v_mfma_f32_16x16x32_bf16 v[220:223], a[166:169], v[208:211], v[220:223]
    v_cvt_pk_bf16_f32 v213, v138, v139
    v_mfma_f32_16x16x32_bf16 v[232:235], a[196:199], v[208:211], v[232:235]
    buffer_load_dwordx4 v[32:35], v9, s[20:23], s51 offen
    v_mfma_f32_16x16x32_bf16 v[228:231], a[186:189], v[208:211], v[228:231]
    v_mfma_f32_16x16x32_bf16 v[240:243], a[216:219], v[208:211], v[240:243]
    v_mfma_f32_16x16x32_bf16 v[236:239], a[206:209], v[208:211], v[236:239]
    buffer_load_dwordx4 v[36:39], v9, s[20:23], s51 offen offset:1024
    v_mfma_f32_16x16x32_bf16 v[244:247], a[226:229], v[208:211], v[244:247]
    v_mfma_f32_16x16x16_bf16 v[216:219], a[160:161], v[212:213], v[216:219]
    buffer_load_dwordx4 v[40:43], v9, s[20:23], s51 offen offset:2048
    v_mfma_f32_16x16x16_bf16 v[224:227], a[180:181], v[212:213], v[224:227]
    v_mfma_f32_16x16x16_bf16 v[220:223], a[170:171], v[212:213], v[220:223]
    s_nop 4
    s_nop 0
    v_cvt_pk_bf16_f32 v216, v216, v217
    v_mfma_f32_16x16x16_bf16 v[232:235], a[200:201], v[212:213], v[232:235]
    buffer_load_dwordx4 v[44:47], v9, s[20:23], s51 offen offset:3072
    buffer_load_dword a233, v5, s[32:35], s3 offen sc1
    v_mfma_f32_16x16x16_bf16 v[228:231], a[190:191], v[212:213], v[228:231]
    v_cvt_pk_bf16_f32 v217, v218, v219
    v_cvt_pk_bf16_f32 v224, v224, v225
    v_mfma_f32_16x16x16_bf16 v[240:243], a[220:221], v[212:213], v[240:243]
    v_cvt_pk_bf16_f32 v218, v220, v221
    v_cvt_pk_bf16_f32 v219, v222, v223
    v_mfma_f32_16x16x16_bf16 v[236:239], a[210:211], v[212:213], v[236:239]
    v_cvt_pk_bf16_f32 v225, v226, v227
    v_cvt_pk_bf16_f32 v232, v232, v233
    v_mfma_f32_16x16x16_bf16 v[244:247], a[230:231], v[212:213], v[244:247]
    ds_write_b128 v248, v[216:219] offset:16384
    v_cvt_pk_bf16_f32 v226, v228, v229
    v_cvt_pk_bf16_f32 v227, v230, v231
    v_cvt_pk_bf16_f32 v233, v234, v235
    v_cvt_pk_bf16_f32 v240, v240, v241
    v_cvt_pk_bf16_f32 v234, v236, v237
    v_cvt_pk_bf16_f32 v235, v238, v239
    v_cvt_pk_bf16_f32 v241, v242, v243
    v_cvt_pk_bf16_f32 v242, v244, v245
    v_cvt_pk_bf16_f32 v243, v246, v247
    ds_write_b128 v249, v[224:227] offset:16384
    ds_write_b128 v250, v[232:235] offset:16384
    ds_write_b128 v251, v[240:243] offset:16384
    v_xor_b32_e64 v4, 0, v3
    s_waitcnt lgkmcnt(0)
    s_barrier
    ds_read_b128 a[32:35], v4
    ds_read_b128 a[36:39], v4 offset:4096
    ds_read_b128 a[40:43], v4 offset:8192
    ds_read_b128 a[44:47], v4 offset:12288
    ds_read_b128 a[48:51], v4 offset:16384
    s_waitcnt vmcnt(17)
    s_nop 0
    v_perm_b32 v112, v52, v48, s42
    v_perm_b32 v113, v60, v56, s42
    v_perm_b32 v114, v68, v64, s42
    v_perm_b32 v115, v76, v72, s42
    s_waitcnt lgkmcnt(0)
    s_nop 0
    v_mfma_f32_16x16x32_bf16 v[120:123], v[112:115], a[32:35], 0
    v_perm_b32 v116, v52, v48, s43
    v_perm_b32 v117, v60, v56, s43
    v_mfma_f32_16x16x32_bf16 v[152:155], v[112:115], a[36:39], 0
    v_perm_b32 v118, v68, v64, s43
    v_perm_b32 v119, v76, v72, s43
    v_mfma_f32_16x16x32_bf16 v[184:187], v[112:115], a[40:43], 0
    v_mfma_f32_16x16x32_bf16 v[216:219], v[112:115], a[44:47], 0
    v_mfma_f32_16x16x32_bf16 a[0:3], v[112:115], a[48:51], 0
    v_xor_b32_e64 v4, 64, v3
    ds_read_b128 a[52:55], v4
    v_mfma_f32_16x16x32_bf16 v[124:127], v[116:119], a[32:35], 0
    v_perm_b32 v112, v53, v49, s42
    v_perm_b32 v113, v61, v57, s42
    v_mfma_f32_16x16x32_bf16 v[156:159], v[116:119], a[36:39], 0
    v_perm_b32 v114, v69, v65, s42
    v_perm_b32 v115, v77, v73, s42
    v_mfma_f32_16x16x32_bf16 v[188:191], v[116:119], a[40:43], 0
    v_mfma_f32_16x16x32_bf16 v[220:223], v[116:119], a[44:47], 0
    v_mfma_f32_16x16x32_bf16 a[4:7], v[116:119], a[48:51], 0
    ds_read_b128 a[56:59], v4 offset:4096
    v_mfma_f32_16x16x32_bf16 v[128:131], v[112:115], a[32:35], 0
    v_perm_b32 v116, v53, v49, s43
    v_perm_b32 v117, v61, v57, s43
    v_mfma_f32_16x16x32_bf16 v[160:163], v[112:115], a[36:39], 0
    v_perm_b32 v118, v69, v65, s43
    v_perm_b32 v119, v77, v73, s43
    v_mfma_f32_16x16x32_bf16 v[192:195], v[112:115], a[40:43], 0
    v_mfma_f32_16x16x32_bf16 v[224:227], v[112:115], a[44:47], 0
    v_mfma_f32_16x16x32_bf16 a[8:11], v[112:115], a[48:51], 0
    ds_read_b128 a[60:63], v4 offset:8192
    v_mfma_f32_16x16x32_bf16 v[132:135], v[116:119], a[32:35], 0
    v_perm_b32 v112, v54, v50, s42
    v_perm_b32 v113, v62, v58, s42
    v_mfma_f32_16x16x32_bf16 v[164:167], v[116:119], a[36:39], 0
    v_perm_b32 v114, v70, v66, s42
    v_perm_b32 v115, v78, v74, s42
    v_mfma_f32_16x16x32_bf16 v[196:199], v[116:119], a[40:43], 0
    v_mfma_f32_16x16x32_bf16 v[228:231], v[116:119], a[44:47], 0
    v_mfma_f32_16x16x32_bf16 a[12:15], v[116:119], a[48:51], 0
    ds_read_b128 a[64:67], v4 offset:12288
    v_mfma_f32_16x16x32_bf16 v[136:139], v[112:115], a[32:35], 0
    v_perm_b32 v116, v54, v50, s43
    v_perm_b32 v117, v62, v58, s43
    v_mfma_f32_16x16x32_bf16 v[168:171], v[112:115], a[36:39], 0
    v_perm_b32 v118, v70, v66, s43
    v_perm_b32 v119, v78, v74, s43
    v_mfma_f32_16x16x32_bf16 v[200:203], v[112:115], a[40:43], 0
    v_mfma_f32_16x16x32_bf16 v[232:235], v[112:115], a[44:47], 0
    v_mfma_f32_16x16x32_bf16 a[16:19], v[112:115], a[48:51], 0
    ds_read_b128 a[68:71], v4 offset:16384
    v_mfma_f32_16x16x32_bf16 v[140:143], v[116:119], a[32:35], 0
    v_perm_b32 v112, v55, v51, s42
    v_perm_b32 v113, v63, v59, s42
    v_mfma_f32_16x16x32_bf16 v[172:175], v[116:119], a[36:39], 0
    v_perm_b32 v114, v71, v67, s42
    v_perm_b32 v115, v79, v75, s42
    v_mfma_f32_16x16x32_bf16 v[204:207], v[116:119], a[40:43], 0
    v_mfma_f32_16x16x32_bf16 v[236:239], v[116:119], a[44:47], 0
    v_mfma_f32_16x16x32_bf16 a[20:23], v[116:119], a[48:51], 0
    v_mfma_f32_16x16x32_bf16 v[144:147], v[112:115], a[32:35], 0
    v_perm_b32 v116, v55, v51, s43
    v_perm_b32 v117, v63, v59, s43
    v_mfma_f32_16x16x32_bf16 v[176:179], v[112:115], a[36:39], 0
    v_perm_b32 v118, v71, v67, s43
    v_perm_b32 v119, v79, v75, s43
    v_mfma_f32_16x16x32_bf16 v[208:211], v[112:115], a[40:43], 0
    v_mfma_f32_16x16x32_bf16 v[240:243], v[112:115], a[44:47], 0
    v_mfma_f32_16x16x32_bf16 a[24:27], v[112:115], a[48:51], 0
    v_mfma_f32_16x16x32_bf16 v[148:151], v[116:119], a[32:35], 0
    s_waitcnt vmcnt(9)
    s_nop 0
    v_perm_b32 v112, v84, v80, s42
    v_perm_b32 v113, v92, v88, s42
    v_mfma_f32_16x16x32_bf16 v[180:183], v[116:119], a[36:39], 0
    v_perm_b32 v114, v100, v96, s42
    v_perm_b32 v115, v108, v104, s42
    v_mfma_f32_16x16x32_bf16 v[212:215], v[116:119], a[40:43], 0
    s_xor_b32 s51, s52, 98304
    buffer_load_dwordx4 v[48:51], v8, s[20:23], s51 offen
    v_mfma_f32_16x16x32_bf16 v[244:247], v[116:119], a[44:47], 0
    buffer_load_dwordx4 v[52:55], v8, s[20:23], s51 offen offset:1024
    v_mfma_f32_16x16x32_bf16 a[28:31], v[116:119], a[48:51], 0
    s_waitcnt lgkmcnt(0)
    s_nop 0
    v_mfma_f32_16x16x32_bf16 v[120:123], v[112:115], a[52:55], v[120:123]
    v_perm_b32 v116, v84, v80, s43
    v_perm_b32 v117, v92, v88, s43
    v_mfma_f32_16x16x32_bf16 v[152:155], v[112:115], a[56:59], v[152:155]
    v_perm_b32 v118, v100, v96, s43
    v_perm_b32 v119, v108, v104, s43
    v_mfma_f32_16x16x32_bf16 v[184:187], v[112:115], a[60:63], v[184:187]
    buffer_load_dwordx4 v[56:59], v8, s[20:23], s51 offen offset:2048
    v_mfma_f32_16x16x32_bf16 v[216:219], v[112:115], a[64:67], v[216:219]
    buffer_load_dwordx4 v[60:63], v8, s[20:23], s51 offen offset:3072
    v_mfma_f32_16x16x32_bf16 a[0:3], v[112:115], a[68:71], a[0:3]
    v_xor_b32 v4, 128, v3
    ds_read_b128 a[32:35], v4
    v_mfma_f32_16x16x32_bf16 v[124:127], v[116:119], a[52:55], v[124:127]
    v_perm_b32 v112, v85, v81, s42
    v_perm_b32 v113, v93, v89, s42
    v_mfma_f32_16x16x32_bf16 v[156:159], v[116:119], a[56:59], v[156:159]
    v_perm_b32 v114, v101, v97, s42
    v_perm_b32 v115, v109, v105, s42
    v_mfma_f32_16x16x32_bf16 v[188:191], v[116:119], a[60:63], v[188:191]
    buffer_load_dwordx4 v[64:67], v9, s[20:23], s51 offen
    v_mfma_f32_16x16x32_bf16 v[220:223], v[116:119], a[64:67], v[220:223]
    buffer_load_dwordx4 v[68:71], v9, s[20:23], s51 offen offset:1024
    v_mfma_f32_16x16x32_bf16 a[4:7], v[116:119], a[68:71], a[4:7]
    ds_read_b128 a[36:39], v4 offset:4096
    v_mfma_f32_16x16x32_bf16 v[128:131], v[112:115], a[52:55], v[128:131]
    v_perm_b32 v116, v85, v81, s43
    v_perm_b32 v117, v93, v89, s43
    v_mfma_f32_16x16x32_bf16 v[160:163], v[112:115], a[56:59], v[160:163]
    v_perm_b32 v118, v101, v97, s43
    v_perm_b32 v119, v109, v105, s43
    v_mfma_f32_16x16x32_bf16 v[192:195], v[112:115], a[60:63], v[192:195]
    buffer_load_dwordx4 v[72:75], v9, s[20:23], s51 offen offset:2048
    v_mfma_f32_16x16x32_bf16 v[224:227], v[112:115], a[64:67], v[224:227]
    buffer_load_dwordx4 v[76:79], v9, s[20:23], s51 offen offset:3072
    v_mfma_f32_16x16x32_bf16 a[8:11], v[112:115], a[68:71], a[8:11]
    ds_read_b128 a[40:43], v4 offset:8192
    v_mfma_f32_16x16x32_bf16 v[132:135], v[116:119], a[52:55], v[132:135]
    v_perm_b32 v112, v86, v82, s42
    v_perm_b32 v113, v94, v90, s42
    v_mfma_f32_16x16x32_bf16 v[164:167], v[116:119], a[56:59], v[164:167]
    v_perm_b32 v114, v102, v98, s42
    v_perm_b32 v115, v110, v106, s42
    v_mfma_f32_16x16x32_bf16 v[196:199], v[116:119], a[60:63], v[196:199]
    v_mfma_f32_16x16x32_bf16 v[228:231], v[116:119], a[64:67], v[228:231]
    v_mfma_f32_16x16x32_bf16 a[12:15], v[116:119], a[68:71], a[12:15]
    ds_read_b128 a[44:47], v4 offset:12288
    v_mfma_f32_16x16x32_bf16 v[136:139], v[112:115], a[52:55], v[136:139]
    v_perm_b32 v116, v86, v82, s43
    v_perm_b32 v117, v94, v90, s43
    v_mfma_f32_16x16x32_bf16 v[168:171], v[112:115], a[56:59], v[168:171]
    v_perm_b32 v118, v102, v98, s43
    v_perm_b32 v119, v110, v106, s43
    v_mfma_f32_16x16x32_bf16 v[200:203], v[112:115], a[60:63], v[200:203]
    v_mfma_f32_16x16x32_bf16 v[232:235], v[112:115], a[64:67], v[232:235]
    v_mfma_f32_16x16x32_bf16 a[16:19], v[112:115], a[68:71], a[16:19]
    ds_read_b128 a[48:51], v4 offset:16384
    v_mfma_f32_16x16x32_bf16 v[140:143], v[116:119], a[52:55], v[140:143]
    v_perm_b32 v112, v87, v83, s42
    v_perm_b32 v113, v95, v91, s42
    v_mfma_f32_16x16x32_bf16 v[172:175], v[116:119], a[56:59], v[172:175]
    v_perm_b32 v114, v103, v99, s42
    v_perm_b32 v115, v111, v107, s42
    v_mfma_f32_16x16x32_bf16 v[204:207], v[116:119], a[60:63], v[204:207]
    v_mfma_f32_16x16x32_bf16 v[236:239], v[116:119], a[64:67], v[236:239]
    v_mfma_f32_16x16x32_bf16 a[20:23], v[116:119], a[68:71], a[20:23]
    v_mfma_f32_16x16x32_bf16 v[144:147], v[112:115], a[52:55], v[144:147]
    v_perm_b32 v116, v87, v83, s43
    v_perm_b32 v117, v95, v91, s43
    v_mfma_f32_16x16x32_bf16 v[176:179], v[112:115], a[56:59], v[176:179]
    v_perm_b32 v118, v103, v99, s43
    v_perm_b32 v119, v111, v107, s43
    v_mfma_f32_16x16x32_bf16 v[208:211], v[112:115], a[60:63], v[208:211]
    v_mfma_f32_16x16x32_bf16 v[240:243], v[112:115], a[64:67], v[240:243]
    v_mfma_f32_16x16x32_bf16 a[24:27], v[112:115], a[68:71], a[24:27]
    v_mfma_f32_16x16x32_bf16 v[148:151], v[116:119], a[52:55], v[148:151]
    s_waitcnt vmcnt(9)
    s_nop 0
    v_perm_b32 v112, v20, v16, s42
    v_perm_b32 v113, v28, v24, s42
    v_mfma_f32_16x16x32_bf16 v[180:183], v[116:119], a[56:59], v[180:183]
    v_perm_b32 v114, v36, v32, s42
    v_perm_b32 v115, v44, v40, s42
    v_mfma_f32_16x16x32_bf16 v[212:215], v[116:119], a[60:63], v[212:215]
    s_xor_b32 s51, s52, 131072
    buffer_load_dwordx4 v[80:83], v8, s[20:23], s51 offen
    v_mfma_f32_16x16x32_bf16 v[244:247], v[116:119], a[64:67], v[244:247]
    buffer_load_dwordx4 v[84:87], v8, s[20:23], s51 offen offset:1024
    v_mfma_f32_16x16x32_bf16 a[28:31], v[116:119], a[68:71], a[28:31]
    s_waitcnt lgkmcnt(0)
    s_nop 0
    v_mfma_f32_16x16x32_bf16 v[120:123], v[112:115], a[32:35], v[120:123]
    v_perm_b32 v116, v20, v16, s43
    v_perm_b32 v117, v28, v24, s43
    v_mfma_f32_16x16x32_bf16 v[152:155], v[112:115], a[36:39], v[152:155]
    v_perm_b32 v118, v36, v32, s43
    v_perm_b32 v119, v44, v40, s43
    v_mfma_f32_16x16x32_bf16 v[184:187], v[112:115], a[40:43], v[184:187]
    buffer_load_dwordx4 v[88:91], v8, s[20:23], s51 offen offset:2048
    v_mfma_f32_16x16x32_bf16 v[216:219], v[112:115], a[44:47], v[216:219]
    buffer_load_dwordx4 v[92:95], v8, s[20:23], s51 offen offset:3072
    v_mfma_f32_16x16x32_bf16 a[0:3], v[112:115], a[48:51], a[0:3]
    v_xor_b32 v4, 192, v3
    ds_read_b128 a[52:55], v4
    v_mfma_f32_16x16x32_bf16 v[124:127], v[116:119], a[32:35], v[124:127]
    v_perm_b32 v112, v21, v17, s42
    v_perm_b32 v113, v29, v25, s42
    v_mfma_f32_16x16x32_bf16 v[156:159], v[116:119], a[36:39], v[156:159]
    v_perm_b32 v114, v37, v33, s42
    v_perm_b32 v115, v45, v41, s42
    v_mfma_f32_16x16x32_bf16 v[188:191], v[116:119], a[40:43], v[188:191]
    buffer_load_dwordx4 v[96:99], v9, s[20:23], s51 offen
    v_mfma_f32_16x16x32_bf16 v[220:223], v[116:119], a[44:47], v[220:223]
    buffer_load_dwordx4 v[100:103], v9, s[20:23], s51 offen offset:1024
    v_mfma_f32_16x16x32_bf16 a[4:7], v[116:119], a[48:51], a[4:7]
    ds_read_b128 a[56:59], v4 offset:4096
    v_mfma_f32_16x16x32_bf16 v[128:131], v[112:115], a[32:35], v[128:131]
    v_perm_b32 v116, v21, v17, s43
    v_perm_b32 v117, v29, v25, s43
    v_mfma_f32_16x16x32_bf16 v[160:163], v[112:115], a[36:39], v[160:163]
    v_perm_b32 v118, v37, v33, s43
    v_perm_b32 v119, v45, v41, s43
    v_mfma_f32_16x16x32_bf16 v[192:195], v[112:115], a[40:43], v[192:195]
    buffer_load_dwordx4 v[104:107], v9, s[20:23], s51 offen offset:2048
    v_mfma_f32_16x16x32_bf16 v[224:227], v[112:115], a[44:47], v[224:227]
    buffer_load_dwordx4 v[108:111], v9, s[20:23], s51 offen offset:3072
    v_mfma_f32_16x16x32_bf16 a[8:11], v[112:115], a[48:51], a[8:11]
    ds_read_b128 a[60:63], v4 offset:8192
    v_mfma_f32_16x16x32_bf16 v[132:135], v[116:119], a[32:35], v[132:135]
    v_perm_b32 v112, v22, v18, s42
    v_perm_b32 v113, v30, v26, s42
    v_mfma_f32_16x16x32_bf16 v[164:167], v[116:119], a[36:39], v[164:167]
    v_perm_b32 v114, v38, v34, s42
    v_perm_b32 v115, v46, v42, s42
    v_mfma_f32_16x16x32_bf16 v[196:199], v[116:119], a[40:43], v[196:199]
    s_mov_b32 s49, 163840
    v_mfma_f32_16x16x32_bf16 v[228:231], v[116:119], a[44:47], v[228:231]
    v_mfma_f32_16x16x32_bf16 a[12:15], v[116:119], a[48:51], a[12:15]
    ds_read_b128 a[64:67], v4 offset:12288
    v_mfma_f32_16x16x32_bf16 v[136:139], v[112:115], a[32:35], v[136:139]
    v_perm_b32 v116, v22, v18, s43
    v_perm_b32 v117, v30, v26, s43
    v_mfma_f32_16x16x32_bf16 v[168:171], v[112:115], a[36:39], v[168:171]
    v_perm_b32 v118, v38, v34, s43
    v_perm_b32 v119, v46, v42, s43
    v_mfma_f32_16x16x32_bf16 v[200:203], v[112:115], a[40:43], v[200:203]
    v_mul_lo_u32 v12, v254, s49
    v_mfma_f32_16x16x32_bf16 v[232:235], v[112:115], a[44:47], v[232:235]
    v_mfma_f32_16x16x32_bf16 a[16:19], v[112:115], a[48:51], a[16:19]
    ds_read_b128 a[68:71], v4 offset:16384
    v_mfma_f32_16x16x32_bf16 v[140:143], v[116:119], a[32:35], v[140:143]
    v_perm_b32 v112, v23, v19, s42
    v_perm_b32 v113, v31, v27, s42
    v_mfma_f32_16x16x32_bf16 v[172:175], v[116:119], a[36:39], v[172:175]
    v_perm_b32 v114, v39, v35, s42
    v_perm_b32 v115, v47, v43, s42
    v_mfma_f32_16x16x32_bf16 v[204:207], v[116:119], a[40:43], v[204:207]
    v_add_u32_e64 v12, v255, v12
    v_mfma_f32_16x16x32_bf16 v[236:239], v[116:119], a[44:47], v[236:239]
    v_mfma_f32_16x16x32_bf16 a[20:23], v[116:119], a[48:51], a[20:23]
    v_mfma_f32_16x16x32_bf16 v[144:147], v[112:115], a[32:35], v[144:147]
    v_perm_b32 v116, v23, v19, s43
    v_perm_b32 v117, v31, v27, s43
    v_mfma_f32_16x16x32_bf16 v[176:179], v[112:115], a[36:39], v[176:179]
    v_perm_b32 v118, v39, v35, s43
    v_perm_b32 v119, v47, v43, s43
    v_mfma_f32_16x16x32_bf16 v[208:211], v[112:115], a[40:43], v[208:211]
    v_add_u32 v13, 81920, v12
    v_mfma_f32_16x16x32_bf16 v[240:243], v[112:115], a[44:47], v[240:243]
    v_mfma_f32_16x16x32_bf16 a[24:27], v[112:115], a[48:51], a[24:27]
    v_mfma_f32_16x16x32_bf16 v[148:151], v[116:119], a[32:35], v[148:151]
    s_waitcnt vmcnt(8)
    s_nop 0
    v_perm_b32 v112, v52, v48, s42
    v_perm_b32 v113, v60, v56, s42
    v_mfma_f32_16x16x32_bf16 v[180:183], v[116:119], a[36:39], v[180:183]
    v_perm_b32 v114, v68, v64, s42
    v_perm_b32 v115, v76, v72, s42
    v_mfma_f32_16x16x32_bf16 v[212:215], v[116:119], a[40:43], v[212:215]
    s_xor_b32 s51, s52, 163840
    buffer_load_dwordx4 v[16:19], v8, s[20:23], s51 offen
    v_mfma_f32_16x16x32_bf16 v[244:247], v[116:119], a[44:47], v[244:247]
    buffer_load_dwordx4 v[20:23], v8, s[20:23], s51 offen offset:1024
    v_mfma_f32_16x16x32_bf16 a[28:31], v[116:119], a[48:51], a[28:31]
    s_waitcnt lgkmcnt(0)
    s_nop 0
    v_mfma_f32_16x16x32_bf16 v[120:123], v[112:115], a[52:55], v[120:123]
    v_perm_b32 v116, v52, v48, s43
    v_perm_b32 v117, v60, v56, s43
    v_mfma_f32_16x16x32_bf16 v[152:155], v[112:115], a[56:59], v[152:155]
    v_perm_b32 v118, v68, v64, s43
    v_perm_b32 v119, v76, v72, s43
    v_mfma_f32_16x16x32_bf16 v[184:187], v[112:115], a[60:63], v[184:187]
    buffer_load_dwordx4 v[24:27], v8, s[20:23], s51 offen offset:2048
    v_mfma_f32_16x16x32_bf16 v[216:219], v[112:115], a[64:67], v[216:219]
    buffer_load_dwordx4 v[28:31], v8, s[20:23], s51 offen offset:3072
    v_mfma_f32_16x16x32_bf16 a[0:3], v[112:115], a[68:71], a[0:3]
    v_xor_b32 v4, 20480, v3
    ds_read_b128 a[32:35], v4
    v_mfma_f32_16x16x32_bf16 v[124:127], v[116:119], a[52:55], v[124:127]
    v_perm_b32 v112, v53, v49, s42
    v_perm_b32 v113, v61, v57, s42
    v_mfma_f32_16x16x32_bf16 v[156:159], v[116:119], a[56:59], v[156:159]
    v_perm_b32 v114, v69, v65, s42
    v_perm_b32 v115, v77, v73, s42
    v_mfma_f32_16x16x32_bf16 v[188:191], v[116:119], a[60:63], v[188:191]
    buffer_load_dwordx4 v[32:35], v9, s[20:23], s51 offen
    v_mfma_f32_16x16x32_bf16 v[220:223], v[116:119], a[64:67], v[220:223]
    buffer_load_dwordx4 v[36:39], v9, s[20:23], s51 offen offset:1024
    v_mfma_f32_16x16x32_bf16 a[4:7], v[116:119], a[68:71], a[4:7]
    ds_read_b128 a[36:39], v4 offset:4096
    v_mfma_f32_16x16x32_bf16 v[128:131], v[112:115], a[52:55], v[128:131]
    v_perm_b32 v116, v53, v49, s43
    v_perm_b32 v117, v61, v57, s43
    v_mfma_f32_16x16x32_bf16 v[160:163], v[112:115], a[56:59], v[160:163]
    v_perm_b32 v118, v69, v65, s43
    v_perm_b32 v119, v77, v73, s43
    v_mfma_f32_16x16x32_bf16 v[192:195], v[112:115], a[60:63], v[192:195]
    buffer_load_dwordx4 v[40:43], v9, s[20:23], s51 offen offset:2048
    v_mfma_f32_16x16x32_bf16 v[224:227], v[112:115], a[64:67], v[224:227]
    buffer_load_dwordx4 v[44:47], v9, s[20:23], s51 offen offset:3072
    v_mfma_f32_16x16x32_bf16 a[8:11], v[112:115], a[68:71], a[8:11]
    ds_read_b128 a[40:43], v4 offset:8192
    v_mfma_f32_16x16x32_bf16 v[132:135], v[116:119], a[52:55], v[132:135]
    v_perm_b32 v112, v54, v50, s42
    v_perm_b32 v113, v62, v58, s42
    v_mfma_f32_16x16x32_bf16 v[164:167], v[116:119], a[56:59], v[164:167]
    v_perm_b32 v114, v70, v66, s42
    v_perm_b32 v115, v78, v74, s42
    v_mfma_f32_16x16x32_bf16 v[196:199], v[116:119], a[60:63], v[196:199]
    s_mul_i32 s60, s55, 655360
    v_mfma_f32_16x16x32_bf16 v[228:231], v[116:119], a[64:67], v[228:231]
    v_mfma_f32_16x16x32_bf16 a[12:15], v[116:119], a[68:71], a[12:15]
    ds_read_b128 a[44:47], v4 offset:12288
    v_mfma_f32_16x16x32_bf16 v[136:139], v[112:115], a[52:55], v[136:139]
    v_perm_b32 v116, v54, v50, s43
    v_perm_b32 v117, v62, v58, s43
    v_mfma_f32_16x16x32_bf16 v[168:171], v[112:115], a[56:59], v[168:171]
    v_perm_b32 v118, v70, v66, s43
    v_perm_b32 v119, v78, v74, s43
    v_mfma_f32_16x16x32_bf16 v[200:203], v[112:115], a[60:63], v[200:203]
    s_mul_i32 s49, s39, 20480
    v_mfma_f32_16x16x32_bf16 v[232:235], v[112:115], a[64:67], v[232:235]
    v_mfma_f32_16x16x32_bf16 a[16:19], v[112:115], a[68:71], a[16:19]
    ds_read_b128 a[48:51], v4 offset:16384
    v_mfma_f32_16x16x32_bf16 v[140:143], v[116:119], a[52:55], v[140:143]
    v_perm_b32 v112, v55, v51, s42
    v_perm_b32 v113, v63, v59, s42
    v_mfma_f32_16x16x32_bf16 v[172:175], v[116:119], a[56:59], v[172:175]
    v_perm_b32 v114, v71, v67, s42
    v_perm_b32 v115, v79, v75, s42
    v_mfma_f32_16x16x32_bf16 v[204:207], v[116:119], a[60:63], v[204:207]
    s_add_u32 s60, s60, s49
    s_nop 0
    v_mfma_f32_16x16x32_bf16 v[236:239], v[116:119], a[64:67], v[236:239]
    v_mfma_f32_16x16x32_bf16 a[20:23], v[116:119], a[68:71], a[20:23]
    v_mfma_f32_16x16x32_bf16 v[144:147], v[112:115], a[52:55], v[144:147]
    v_perm_b32 v116, v55, v51, s43
    v_perm_b32 v117, v63, v59, s43
    v_mfma_f32_16x16x32_bf16 v[176:179], v[112:115], a[56:59], v[176:179]
    v_perm_b32 v118, v71, v67, s43
    v_perm_b32 v119, v79, v75, s43
    v_mfma_f32_16x16x32_bf16 v[208:211], v[112:115], a[60:63], v[208:211]
    s_lshl_b32 s49, s38, 8
    s_nop 0
    v_mfma_f32_16x16x32_bf16 v[240:243], v[112:115], a[64:67], v[240:243]
    v_mfma_f32_16x16x32_bf16 a[24:27], v[112:115], a[68:71], a[24:27]
    v_mfma_f32_16x16x32_bf16 v[148:151], v[116:119], a[52:55], v[148:151]
    s_waitcnt vmcnt(8)
    s_nop 0
    v_perm_b32 v112, v84, v80, s42
    v_perm_b32 v113, v92, v88, s42
    v_mfma_f32_16x16x32_bf16 v[180:183], v[116:119], a[56:59], v[180:183]
    v_perm_b32 v114, v100, v96, s42
    v_perm_b32 v115, v108, v104, s42
    v_mfma_f32_16x16x32_bf16 v[212:215], v[116:119], a[60:63], v[212:215]
    s_xor_b32 s51, s52, 196608
    buffer_load_dwordx4 v[48:51], v8, s[20:23], s51 offen
    v_mfma_f32_16x16x32_bf16 v[244:247], v[116:119], a[64:67], v[244:247]
    buffer_load_dwordx4 v[52:55], v8, s[20:23], s51 offen offset:1024
    v_mfma_f32_16x16x32_bf16 a[28:31], v[116:119], a[68:71], a[28:31]
    s_waitcnt lgkmcnt(0)
    s_nop 0
    v_mfma_f32_16x16x32_bf16 v[120:123], v[112:115], a[32:35], v[120:123]
    v_perm_b32 v116, v84, v80, s43
    v_perm_b32 v117, v92, v88, s43
    v_mfma_f32_16x16x32_bf16 v[152:155], v[112:115], a[36:39], v[152:155]
    v_perm_b32 v118, v100, v96, s43
    v_perm_b32 v119, v108, v104, s43
    v_mfma_f32_16x16x32_bf16 v[184:187], v[112:115], a[40:43], v[184:187]
    buffer_load_dwordx4 v[56:59], v8, s[20:23], s51 offen offset:2048
    v_mfma_f32_16x16x32_bf16 v[216:219], v[112:115], a[44:47], v[216:219]
    buffer_load_dwordx4 v[60:63], v8, s[20:23], s51 offen offset:3072
    v_mfma_f32_16x16x32_bf16 a[0:3], v[112:115], a[48:51], a[0:3]
    v_xor_b32 v4, 20544, v3
    ds_read_b128 a[52:55], v4
    v_mfma_f32_16x16x32_bf16 v[124:127], v[116:119], a[32:35], v[124:127]
    v_perm_b32 v112, v85, v81, s42
    v_perm_b32 v113, v93, v89, s42
    v_mfma_f32_16x16x32_bf16 v[156:159], v[116:119], a[36:39], v[156:159]
    v_perm_b32 v114, v101, v97, s42
    v_perm_b32 v115, v109, v105, s42
    v_mfma_f32_16x16x32_bf16 v[188:191], v[116:119], a[40:43], v[188:191]
    buffer_load_dwordx4 v[64:67], v9, s[20:23], s51 offen
    v_mfma_f32_16x16x32_bf16 v[220:223], v[116:119], a[44:47], v[220:223]
    buffer_load_dwordx4 v[68:71], v9, s[20:23], s51 offen offset:1024
    v_mfma_f32_16x16x32_bf16 a[4:7], v[116:119], a[48:51], a[4:7]
    ds_read_b128 a[56:59], v4 offset:4096
    v_mfma_f32_16x16x32_bf16 v[128:131], v[112:115], a[32:35], v[128:131]
    v_perm_b32 v116, v85, v81, s43
    v_perm_b32 v117, v93, v89, s43
    v_mfma_f32_16x16x32_bf16 v[160:163], v[112:115], a[36:39], v[160:163]
    v_perm_b32 v118, v101, v97, s43
    v_perm_b32 v119, v109, v105, s43
    v_mfma_f32_16x16x32_bf16 v[192:195], v[112:115], a[40:43], v[192:195]
    buffer_load_dwordx4 v[72:75], v9, s[20:23], s51 offen offset:2048
    v_mfma_f32_16x16x32_bf16 v[224:227], v[112:115], a[44:47], v[224:227]
    buffer_load_dwordx4 v[76:79], v9, s[20:23], s51 offen offset:3072
    v_mfma_f32_16x16x32_bf16 a[8:11], v[112:115], a[48:51], a[8:11]
    ds_read_b128 a[60:63], v4 offset:8192
    v_mfma_f32_16x16x32_bf16 v[132:135], v[116:119], a[32:35], v[132:135]
    v_perm_b32 v112, v86, v82, s42
    v_perm_b32 v113, v94, v90, s42
    v_mfma_f32_16x16x32_bf16 v[164:167], v[116:119], a[36:39], v[164:167]
    v_perm_b32 v114, v102, v98, s42
    v_perm_b32 v115, v110, v106, s42
    v_mfma_f32_16x16x32_bf16 v[196:199], v[116:119], a[40:43], v[196:199]
    s_add_u32 s60, s60, s49
    s_nop 0
    v_mfma_f32_16x16x32_bf16 v[228:231], v[116:119], a[44:47], v[228:231]
    v_mfma_f32_16x16x32_bf16 a[12:15], v[116:119], a[48:51], a[12:15]
    ds_read_b128 a[64:67], v4 offset:12288
    v_mfma_f32_16x16x32_bf16 v[136:139], v[112:115], a[32:35], v[136:139]
    v_perm_b32 v116, v86, v82, s43
    v_perm_b32 v117, v94, v90, s43
    v_mfma_f32_16x16x32_bf16 v[168:171], v[112:115], a[36:39], v[168:171]
    v_perm_b32 v118, v102, v98, s43
    v_perm_b32 v119, v110, v106, s43
    v_mfma_f32_16x16x32_bf16 v[200:203], v[112:115], a[40:43], v[200:203]
    s_add_u32 s60, s60, 1048576
    v_mfma_f32_16x16x32_bf16 v[232:235], v[112:115], a[44:47], v[232:235]
    v_mfma_f32_16x16x32_bf16 a[16:19], v[112:115], a[48:51], a[16:19]
    ds_read_b128 a[68:71], v4 offset:16384
    v_mfma_f32_16x16x32_bf16 v[140:143], v[116:119], a[32:35], v[140:143]
    v_perm_b32 v112, v87, v83, s42
    v_perm_b32 v113, v95, v91, s42
    v_mfma_f32_16x16x32_bf16 v[172:175], v[116:119], a[36:39], v[172:175]
    v_perm_b32 v114, v103, v99, s42
    v_perm_b32 v115, v111, v107, s42
    v_mfma_f32_16x16x32_bf16 v[204:207], v[116:119], a[40:43], v[204:207]
    s_add_u32 s61, s60, 4096
    v_mfma_f32_16x16x32_bf16 v[236:239], v[116:119], a[44:47], v[236:239]
    v_mfma_f32_16x16x32_bf16 a[20:23], v[116:119], a[48:51], a[20:23]
    v_mfma_f32_16x16x32_bf16 v[144:147], v[112:115], a[32:35], v[144:147]
    v_perm_b32 v116, v87, v83, s43
    v_perm_b32 v117, v95, v91, s43
    v_mfma_f32_16x16x32_bf16 v[176:179], v[112:115], a[36:39], v[176:179]
    v_perm_b32 v118, v103, v99, s43
    v_perm_b32 v119, v111, v107, s43
    v_mfma_f32_16x16x32_bf16 v[208:211], v[112:115], a[40:43], v[208:211]
    s_add_u32 s62, s60, 8192
    v_mfma_f32_16x16x32_bf16 v[240:243], v[112:115], a[44:47], v[240:243]
    v_mfma_f32_16x16x32_bf16 a[24:27], v[112:115], a[48:51], a[24:27]
    v_mfma_f32_16x16x32_bf16 v[148:151], v[116:119], a[32:35], v[148:151]
    s_waitcnt vmcnt(8)
    s_nop 0
    v_perm_b32 v112, v20, v16, s42
    v_perm_b32 v113, v28, v24, s42
    v_mfma_f32_16x16x32_bf16 v[180:183], v[116:119], a[36:39], v[180:183]
    v_perm_b32 v114, v36, v32, s42
    v_perm_b32 v115, v44, v40, s42
    v_mfma_f32_16x16x32_bf16 v[212:215], v[116:119], a[40:43], v[212:215]
    s_xor_b32 s51, s52, 229376
    buffer_load_dwordx4 v[80:83], v8, s[20:23], s51 offen
    v_mfma_f32_16x16x32_bf16 v[244:247], v[116:119], a[44:47], v[244:247]
    buffer_load_dwordx4 v[84:87], v8, s[20:23], s51 offen offset:1024
    v_mfma_f32_16x16x32_bf16 a[28:31], v[116:119], a[48:51], a[28:31]
    s_waitcnt lgkmcnt(0)
    s_nop 0
    v_mfma_f32_16x16x32_bf16 v[120:123], v[112:115], a[52:55], v[120:123]
    v_perm_b32 v116, v20, v16, s43
    v_perm_b32 v117, v28, v24, s43
    v_mfma_f32_16x16x32_bf16 v[152:155], v[112:115], a[56:59], v[152:155]
    v_perm_b32 v118, v36, v32, s43
    v_perm_b32 v119, v44, v40, s43
    v_mfma_f32_16x16x32_bf16 v[184:187], v[112:115], a[60:63], v[184:187]
    buffer_load_dwordx4 v[88:91], v8, s[20:23], s51 offen offset:2048
    v_mfma_f32_16x16x32_bf16 v[216:219], v[112:115], a[64:67], v[216:219]
    buffer_load_dwordx4 v[92:95], v8, s[20:23], s51 offen offset:3072
    v_mfma_f32_16x16x32_bf16 a[0:3], v[112:115], a[68:71], a[0:3]
    v_xor_b32 v4, 20608, v3
    ds_read_b128 a[32:35], v4
    v_mfma_f32_16x16x32_bf16 v[124:127], v[116:119], a[52:55], v[124:127]
    v_perm_b32 v112, v21, v17, s42
    v_perm_b32 v113, v29, v25, s42
    v_mfma_f32_16x16x32_bf16 v[156:159], v[116:119], a[56:59], v[156:159]
    v_perm_b32 v114, v37, v33, s42
    v_perm_b32 v115, v45, v41, s42
    v_mfma_f32_16x16x32_bf16 v[188:191], v[116:119], a[60:63], v[188:191]
    buffer_load_dwordx4 v[96:99], v9, s[20:23], s51 offen
    v_mfma_f32_16x16x32_bf16 v[220:223], v[116:119], a[64:67], v[220:223]
    buffer_load_dwordx4 v[100:103], v9, s[20:23], s51 offen offset:1024
    v_mfma_f32_16x16x32_bf16 a[4:7], v[116:119], a[68:71], a[4:7]
    ds_read_b128 a[36:39], v4 offset:4096
    v_mfma_f32_16x16x32_bf16 v[128:131], v[112:115], a[52:55], v[128:131]
    v_perm_b32 v116, v21, v17, s43
    v_perm_b32 v117, v29, v25, s43
    v_mfma_f32_16x16x32_bf16 v[160:163], v[112:115], a[56:59], v[160:163]
    v_perm_b32 v118, v37, v33, s43
    v_perm_b32 v119, v45, v41, s43
    v_mfma_f32_16x16x32_bf16 v[192:195], v[112:115], a[60:63], v[192:195]
    buffer_load_dwordx4 v[104:107], v9, s[20:23], s51 offen offset:2048
    v_mfma_f32_16x16x32_bf16 v[224:227], v[112:115], a[64:67], v[224:227]
    buffer_load_dwordx4 v[108:111], v9, s[20:23], s51 offen offset:3072
    v_mfma_f32_16x16x32_bf16 a[8:11], v[112:115], a[68:71], a[8:11]
    ds_read_b128 a[40:43], v4 offset:8192
    v_mfma_f32_16x16x32_bf16 v[132:135], v[116:119], a[52:55], v[132:135]
    v_perm_b32 v112, v22, v18, s42
    v_perm_b32 v113, v30, v26, s42
    v_mfma_f32_16x16x32_bf16 v[164:167], v[116:119], a[56:59], v[164:167]
    v_perm_b32 v114, v38, v34, s42
    v_perm_b32 v115, v46, v42, s42
    v_mfma_f32_16x16x32_bf16 v[196:199], v[116:119], a[60:63], v[196:199]
    s_add_u32 s45, s60, 12288
    v_mfma_f32_16x16x32_bf16 v[228:231], v[116:119], a[64:67], v[228:231]
    v_mfma_f32_16x16x32_bf16 a[12:15], v[116:119], a[68:71], a[12:15]
    ds_read_b128 a[44:47], v4 offset:12288
    v_mfma_f32_16x16x32_bf16 v[136:139], v[112:115], a[52:55], v[136:139]
    v_perm_b32 v116, v22, v18, s43
    v_perm_b32 v117, v30, v26, s43
    v_mfma_f32_16x16x32_bf16 v[168:171], v[112:115], a[56:59], v[168:171]
    v_perm_b32 v118, v38, v34, s43
    v_perm_b32 v119, v46, v42, s43
    v_mfma_f32_16x16x32_bf16 v[200:203], v[112:115], a[60:63], v[200:203]
    s_add_u32 s44, s60, 16384
    v_mfma_f32_16x16x32_bf16 v[232:235], v[112:115], a[64:67], v[232:235]
    v_mfma_f32_16x16x32_bf16 a[16:19], v[112:115], a[68:71], a[16:19]
    ds_read_b128 a[48:51], v4 offset:16384
    v_mfma_f32_16x16x32_bf16 v[140:143], v[116:119], a[52:55], v[140:143]
    v_perm_b32 v112, v23, v19, s42
    v_perm_b32 v113, v31, v27, s42
    v_mfma_f32_16x16x32_bf16 v[172:175], v[116:119], a[56:59], v[172:175]
    v_perm_b32 v114, v39, v35, s42
    v_perm_b32 v115, v47, v43, s42
    v_mfma_f32_16x16x32_bf16 v[204:207], v[116:119], a[60:63], v[204:207]
    v_mov_b32_e64 v7, 0x40000000
    v_mfma_f32_16x16x32_bf16 v[236:239], v[116:119], a[64:67], v[236:239]
    v_mfma_f32_16x16x32_bf16 a[20:23], v[116:119], a[68:71], a[20:23]
    v_mfma_f32_16x16x32_bf16 v[144:147], v[112:115], a[52:55], v[144:147]
    v_perm_b32 v116, v23, v19, s43
    v_perm_b32 v117, v31, v27, s43
    v_mfma_f32_16x16x32_bf16 v[176:179], v[112:115], a[56:59], v[176:179]
    v_perm_b32 v118, v39, v35, s43
    v_perm_b32 v119, v47, v43, s43
    v_mfma_f32_16x16x32_bf16 v[208:211], v[112:115], a[60:63], v[208:211]
    v_lshlrev_b32_e64 v248, 1, v254
    v_mfma_f32_16x16x32_bf16 v[240:243], v[112:115], a[64:67], v[240:243]
    v_mfma_f32_16x16x32_bf16 a[24:27], v[112:115], a[68:71], a[24:27]
    v_mfma_f32_16x16x32_bf16 v[148:151], v[116:119], a[52:55], v[148:151]
    s_waitcnt vmcnt(8)
    s_nop 0
    v_perm_b32 v112, v52, v48, s42
    v_perm_b32 v113, v60, v56, s42
    v_mfma_f32_16x16x32_bf16 v[180:183], v[116:119], a[56:59], v[180:183]
    v_perm_b32 v114, v68, v64, s42
    v_perm_b32 v115, v76, v72, s42
    v_mfma_f32_16x16x32_bf16 v[212:215], v[116:119], a[60:63], v[212:215]
    s_xor_b32 s51, s52, 262144
    buffer_load_dwordx4 v[16:19], v8, s[20:23], s51 offen
    v_mfma_f32_16x16x32_bf16 v[244:247], v[116:119], a[64:67], v[244:247]
    buffer_load_dwordx4 v[20:23], v8, s[20:23], s51 offen offset:1024
    v_mfma_f32_16x16x32_bf16 a[28:31], v[116:119], a[68:71], a[28:31]
    s_waitcnt lgkmcnt(0)
    s_nop 0
    v_mfma_f32_16x16x32_bf16 v[120:123], v[112:115], a[32:35], v[120:123]
    v_perm_b32 v116, v52, v48, s43
    v_perm_b32 v117, v60, v56, s43
    v_mfma_f32_16x16x32_bf16 v[152:155], v[112:115], a[36:39], v[152:155]
    v_perm_b32 v118, v68, v64, s43
    v_perm_b32 v119, v76, v72, s43
    v_mfma_f32_16x16x32_bf16 v[184:187], v[112:115], a[40:43], v[184:187]
    buffer_load_dwordx4 v[24:27], v8, s[20:23], s51 offen offset:2048
    v_mfma_f32_16x16x32_bf16 v[216:219], v[112:115], a[44:47], v[216:219]
    buffer_load_dwordx4 v[28:31], v8, s[20:23], s51 offen offset:3072
    v_mfma_f32_16x16x32_bf16 a[0:3], v[112:115], a[48:51], a[0:3]
    v_xor_b32 v4, 20672, v3
    ds_read_b128 a[52:55], v4
    v_mfma_f32_16x16x32_bf16 v[124:127], v[116:119], a[32:35], v[124:127]
    v_perm_b32 v112, v53, v49, s42
    v_perm_b32 v113, v61, v57, s42
    v_mfma_f32_16x16x32_bf16 v[156:159], v[116:119], a[36:39], v[156:159]
    v_perm_b32 v114, v69, v65, s42
    v_perm_b32 v115, v77, v73, s42
    v_mfma_f32_16x16x32_bf16 v[188:191], v[116:119], a[40:43], v[188:191]
    buffer_load_dwordx4 v[32:35], v9, s[20:23], s51 offen
    v_mfma_f32_16x16x32_bf16 v[220:223], v[116:119], a[44:47], v[220:223]
    buffer_load_dwordx4 v[36:39], v9, s[20:23], s51 offen offset:1024
    v_mfma_f32_16x16x32_bf16 a[4:7], v[116:119], a[48:51], a[4:7]
    ds_read_b128 a[56:59], v4 offset:4096
    v_mfma_f32_16x16x32_bf16 v[128:131], v[112:115], a[32:35], v[128:131]
    v_perm_b32 v116, v53, v49, s43
    v_perm_b32 v117, v61, v57, s43
    v_mfma_f32_16x16x32_bf16 v[160:163], v[112:115], a[36:39], v[160:163]
    v_perm_b32 v118, v69, v65, s43
    v_perm_b32 v119, v77, v73, s43
    v_mfma_f32_16x16x32_bf16 v[192:195], v[112:115], a[40:43], v[192:195]
    buffer_load_dwordx4 v[40:43], v9, s[20:23], s51 offen offset:2048
    v_mfma_f32_16x16x32_bf16 v[224:227], v[112:115], a[44:47], v[224:227]
    buffer_load_dwordx4 v[44:47], v9, s[20:23], s51 offen offset:3072
    v_mfma_f32_16x16x32_bf16 a[8:11], v[112:115], a[48:51], a[8:11]
    ds_read_b128 a[60:63], v4 offset:8192
    v_mfma_f32_16x16x32_bf16 v[132:135], v[116:119], a[32:35], v[132:135]
    v_perm_b32 v112, v54, v50, s42
    v_perm_b32 v113, v62, v58, s42
    v_mfma_f32_16x16x32_bf16 v[164:167], v[116:119], a[36:39], v[164:167]
    v_perm_b32 v114, v70, v66, s42
    v_perm_b32 v115, v78, v74, s42
    v_mfma_f32_16x16x32_bf16 v[196:199], v[116:119], a[40:43], v[196:199]
    v_add_u32_e64 v248, 0, v248
    v_mfma_f32_16x16x32_bf16 v[228:231], v[116:119], a[44:47], v[228:231]
    v_mfma_f32_16x16x32_bf16 a[12:15], v[116:119], a[48:51], a[12:15]
    ds_read_b128 a[64:67], v4 offset:12288
    v_mfma_f32_16x16x32_bf16 v[136:139], v[112:115], a[32:35], v[136:139]
    v_perm_b32 v116, v54, v50, s43
    v_perm_b32 v117, v62, v58, s43
    v_mfma_f32_16x16x32_bf16 v[168:171], v[112:115], a[36:39], v[168:171]
    v_perm_b32 v118, v70, v66, s43
    v_perm_b32 v119, v78, v74, s43
    v_mfma_f32_16x16x32_bf16 v[200:203], v[112:115], a[40:43], v[200:203]
    v_cmp_eq_u32 vcc, s38, v248
    s_nop 0
    v_mfma_f32_16x16x32_bf16 v[232:235], v[112:115], a[44:47], v[232:235]
    v_mfma_f32_16x16x32_bf16 a[16:19], v[112:115], a[48:51], a[16:19]
    ds_read_b128 a[68:71], v4 offset:16384
    v_mfma_f32_16x16x32_bf16 v[140:143], v[116:119], a[32:35], v[140:143]
    v_perm_b32 v112, v55, v51, s42
    v_perm_b32 v113, v63, v59, s42
    v_mfma_f32_16x16x32_bf16 v[172:175], v[116:119], a[36:39], v[172:175]
    v_perm_b32 v114, v71, v67, s42
    v_perm_b32 v115, v79, v75, s42
    v_mfma_f32_16x16x32_bf16 v[204:207], v[116:119], a[40:43], v[204:207]
    v_cndmask_b32 v12, v12, v7, vcc
    s_nop 0
    v_mfma_f32_16x16x32_bf16 v[236:239], v[116:119], a[44:47], v[236:239]
    v_mfma_f32_16x16x32_bf16 a[20:23], v[116:119], a[48:51], a[20:23]
    v_mfma_f32_16x16x32_bf16 v[144:147], v[112:115], a[32:35], v[144:147]
    v_perm_b32 v116, v55, v51, s43
    v_perm_b32 v117, v63, v59, s43
    v_mfma_f32_16x16x32_bf16 v[176:179], v[112:115], a[36:39], v[176:179]
    v_perm_b32 v118, v71, v67, s43
    v_perm_b32 v119, v79, v75, s43
    v_mfma_f32_16x16x32_bf16 v[208:211], v[112:115], a[40:43], v[208:211]
    v_lshlrev_b32_e64 v248, 1, v254
    v_mfma_f32_16x16x32_bf16 v[240:243], v[112:115], a[44:47], v[240:243]
    v_mfma_f32_16x16x32_bf16 a[24:27], v[112:115], a[48:51], a[24:27]
    v_mfma_f32_16x16x32_bf16 v[148:151], v[116:119], a[32:35], v[148:151]
    s_waitcnt vmcnt(8)
    s_nop 0
    v_perm_b32 v112, v84, v80, s42
    v_perm_b32 v113, v92, v88, s42
    v_mfma_f32_16x16x32_bf16 v[180:183], v[116:119], a[36:39], v[180:183]
    v_perm_b32 v114, v100, v96, s42
    v_perm_b32 v115, v108, v104, s42
    v_mfma_f32_16x16x32_bf16 v[212:215], v[116:119], a[40:43], v[212:215]
    s_xor_b32 s51, s52, 294912
    buffer_load_dwordx4 v[48:51], v8, s[20:23], s51 offen
    v_mfma_f32_16x16x32_bf16 v[244:247], v[116:119], a[44:47], v[244:247]
    buffer_load_dwordx4 v[52:55], v8, s[20:23], s51 offen offset:1024
    v_mfma_f32_16x16x32_bf16 a[28:31], v[116:119], a[48:51], a[28:31]
    s_waitcnt lgkmcnt(0)
    s_nop 0
    v_mfma_f32_16x16x32_bf16 v[120:123], v[112:115], a[52:55], v[120:123]
    v_perm_b32 v116, v84, v80, s43
    v_perm_b32 v117, v92, v88, s43
    v_mfma_f32_16x16x32_bf16 v[152:155], v[112:115], a[56:59], v[152:155]
    v_perm_b32 v118, v100, v96, s43
    v_perm_b32 v119, v108, v104, s43
    v_mfma_f32_16x16x32_bf16 v[184:187], v[112:115], a[60:63], v[184:187]
    buffer_load_dwordx4 v[56:59], v8, s[20:23], s51 offen offset:2048
    v_mfma_f32_16x16x32_bf16 v[216:219], v[112:115], a[64:67], v[216:219]
    buffer_load_dwordx4 v[60:63], v8, s[20:23], s51 offen offset:3072
    v_mfma_f32_16x16x32_bf16 a[0:3], v[112:115], a[68:71], a[0:3]
    v_xor_b32 v4, 40960, v3
    ds_read_b128 a[32:35], v4
    v_mfma_f32_16x16x32_bf16 v[124:127], v[116:119], a[52:55], v[124:127]
    v_perm_b32 v112, v85, v81, s42
    v_perm_b32 v113, v93, v89, s42
    v_mfma_f32_16x16x32_bf16 v[156:159], v[116:119], a[56:59], v[156:159]
    v_perm_b32 v114, v101, v97, s42
    v_perm_b32 v115, v109, v105, s42
    v_mfma_f32_16x16x32_bf16 v[188:191], v[116:119], a[60:63], v[188:191]
    buffer_load_dwordx4 v[64:67], v9, s[20:23], s51 offen
    v_mfma_f32_16x16x32_bf16 v[220:223], v[116:119], a[64:67], v[220:223]
    buffer_load_dwordx4 v[68:71], v9, s[20:23], s51 offen offset:1024
    v_mfma_f32_16x16x32_bf16 a[4:7], v[116:119], a[68:71], a[4:7]
    ds_read_b128 a[36:39], v4 offset:4096
    v_mfma_f32_16x16x32_bf16 v[128:131], v[112:115], a[52:55], v[128:131]
    v_perm_b32 v116, v85, v81, s43
    v_perm_b32 v117, v93, v89, s43
    v_mfma_f32_16x16x32_bf16 v[160:163], v[112:115], a[56:59], v[160:163]
    v_perm_b32 v118, v101, v97, s43
    v_perm_b32 v119, v109, v105, s43
    v_mfma_f32_16x16x32_bf16 v[192:195], v[112:115], a[60:63], v[192:195]
    buffer_load_dwordx4 v[72:75], v9, s[20:23], s51 offen offset:2048
    v_mfma_f32_16x16x32_bf16 v[224:227], v[112:115], a[64:67], v[224:227]
    buffer_load_dwordx4 v[76:79], v9, s[20:23], s51 offen offset:3072
    v_mfma_f32_16x16x32_bf16 a[8:11], v[112:115], a[68:71], a[8:11]
    ds_read_b128 a[40:43], v4 offset:8192
    v_mfma_f32_16x16x32_bf16 v[132:135], v[116:119], a[52:55], v[132:135]
    v_perm_b32 v112, v86, v82, s42
    v_perm_b32 v113, v94, v90, s42
    v_mfma_f32_16x16x32_bf16 v[164:167], v[116:119], a[56:59], v[164:167]
    v_perm_b32 v114, v102, v98, s42
    v_perm_b32 v115, v110, v106, s42
    v_mfma_f32_16x16x32_bf16 v[196:199], v[116:119], a[60:63], v[196:199]
    v_add_u32_e64 v248, 1, v248
    v_mfma_f32_16x16x32_bf16 v[228:231], v[116:119], a[64:67], v[228:231]
    v_mfma_f32_16x16x32_bf16 a[12:15], v[116:119], a[68:71], a[12:15]
    ds_read_b128 a[44:47], v4 offset:12288
    v_mfma_f32_16x16x32_bf16 v[136:139], v[112:115], a[52:55], v[136:139]
    v_perm_b32 v116, v86, v82, s43
    v_perm_b32 v117, v94, v90, s43
    v_mfma_f32_16x16x32_bf16 v[168:171], v[112:115], a[56:59], v[168:171]
    v_perm_b32 v118, v102, v98, s43
    v_perm_b32 v119, v110, v106, s43
    v_mfma_f32_16x16x32_bf16 v[200:203], v[112:115], a[60:63], v[200:203]
    v_cmp_eq_u32 vcc, s38, v248
    s_nop 0
    v_mfma_f32_16x16x32_bf16 v[232:235], v[112:115], a[64:67], v[232:235]
    v_mfma_f32_16x16x32_bf16 a[16:19], v[112:115], a[68:71], a[16:19]
    ds_read_b128 a[48:51], v4 offset:16384
    v_mfma_f32_16x16x32_bf16 v[140:143], v[116:119], a[52:55], v[140:143]
    v_perm_b32 v112, v87, v83, s42
    v_perm_b32 v113, v95, v91, s42
    v_mfma_f32_16x16x32_bf16 v[172:175], v[116:119], a[56:59], v[172:175]
    v_perm_b32 v114, v103, v99, s42
    v_perm_b32 v115, v111, v107, s42
    v_mfma_f32_16x16x32_bf16 v[204:207], v[116:119], a[60:63], v[204:207]
    v_cndmask_b32 v13, v13, v7, vcc
    s_nop 0
    v_mfma_f32_16x16x32_bf16 v[236:239], v[116:119], a[64:67], v[236:239]
    v_mfma_f32_16x16x32_bf16 a[20:23], v[116:119], a[68:71], a[20:23]
    v_mfma_f32_16x16x32_bf16 v[144:147], v[112:115], a[52:55], v[144:147]
    v_perm_b32 v116, v87, v83, s43
    v_perm_b32 v117, v95, v91, s43
    v_mfma_f32_16x16x32_bf16 v[176:179], v[112:115], a[56:59], v[176:179]
    v_perm_b32 v118, v103, v99, s43
    v_perm_b32 v119, v111, v107, s43
    v_mfma_f32_16x16x32_bf16 v[208:211], v[112:115], a[60:63], v[208:211]
    v_mfma_f32_16x16x32_bf16 v[240:243], v[112:115], a[64:67], v[240:243]
    v_mfma_f32_16x16x32_bf16 a[24:27], v[112:115], a[68:71], a[24:27]
    v_mfma_f32_16x16x32_bf16 v[148:151], v[116:119], a[52:55], v[148:151]
    s_waitcnt vmcnt(8)
    s_nop 0
    v_perm_b32 v112, v20, v16, s42
    v_perm_b32 v113, v28, v24, s42
    v_mfma_f32_16x16x32_bf16 v[180:183], v[116:119], a[56:59], v[180:183]
    v_perm_b32 v114, v36, v32, s42
    v_perm_b32 v115, v44, v40, s42
    v_mfma_f32_16x16x32_bf16 v[212:215], v[116:119], a[60:63], v[212:215]
    s_xor_b32 s51, s52, 327680
    buffer_load_dwordx4 v[80:83], v8, s[20:23], s51 offen
    v_mfma_f32_16x16x32_bf16 v[244:247], v[116:119], a[64:67], v[244:247]
    buffer_load_dwordx4 v[84:87], v8, s[20:23], s51 offen offset:1024
    v_mfma_f32_16x16x32_bf16 a[28:31], v[116:119], a[68:71], a[28:31]
    s_waitcnt lgkmcnt(0)
    s_nop 0
    v_mfma_f32_16x16x32_bf16 v[120:123], v[112:115], a[32:35], v[120:123]
    v_perm_b32 v116, v20, v16, s43
    v_perm_b32 v117, v28, v24, s43
    v_mfma_f32_16x16x32_bf16 v[152:155], v[112:115], a[36:39], v[152:155]
    v_perm_b32 v118, v36, v32, s43
    v_perm_b32 v119, v44, v40, s43
    v_mfma_f32_16x16x32_bf16 v[184:187], v[112:115], a[40:43], v[184:187]
    buffer_load_dwordx4 v[88:91], v8, s[20:23], s51 offen offset:2048
    v_mfma_f32_16x16x32_bf16 v[216:219], v[112:115], a[44:47], v[216:219]
    buffer_load_dwordx4 v[92:95], v8, s[20:23], s51 offen offset:3072
    v_mfma_f32_16x16x32_bf16 a[0:3], v[112:115], a[48:51], a[0:3]
    v_xor_b32 v4, 41024, v3
    ds_read_b128 a[52:55], v4
    v_mfma_f32_16x16x32_bf16 v[124:127], v[116:119], a[32:35], v[124:127]
    v_perm_b32 v112, v21, v17, s42
    v_perm_b32 v113, v29, v25, s42
    v_mfma_f32_16x16x32_bf16 v[156:159], v[116:119], a[36:39], v[156:159]
    v_perm_b32 v114, v37, v33, s42
    v_perm_b32 v115, v45, v41, s42
    v_mfma_f32_16x16x32_bf16 v[188:191], v[116:119], a[40:43], v[188:191]
    buffer_load_dwordx4 v[96:99], v9, s[20:23], s51 offen
    v_mfma_f32_16x16x32_bf16 v[220:223], v[116:119], a[44:47], v[220:223]
    buffer_load_dwordx4 v[100:103], v9, s[20:23], s51 offen offset:1024
    v_mfma_f32_16x16x32_bf16 a[4:7], v[116:119], a[48:51], a[4:7]
    ds_read_b128 a[56:59], v4 offset:4096
    v_mfma_f32_16x16x32_bf16 v[128:131], v[112:115], a[32:35], v[128:131]
    v_perm_b32 v116, v21, v17, s43
    v_perm_b32 v117, v29, v25, s43
    v_mfma_f32_16x16x32_bf16 v[160:163], v[112:115], a[36:39], v[160:163]
    v_perm_b32 v118, v37, v33, s43
    v_perm_b32 v119, v45, v41, s43
    v_mfma_f32_16x16x32_bf16 v[192:195], v[112:115], a[40:43], v[192:195]
    buffer_load_dwordx4 v[104:107], v9, s[20:23], s51 offen offset:2048
    v_mfma_f32_16x16x32_bf16 v[224:227], v[112:115], a[44:47], v[224:227]
    buffer_load_dwordx4 v[108:111], v9, s[20:23], s51 offen offset:3072
    v_mfma_f32_16x16x32_bf16 a[8:11], v[112:115], a[48:51], a[8:11]
    ds_read_b128 a[60:63], v4 offset:8192
    v_mfma_f32_16x16x32_bf16 v[132:135], v[116:119], a[32:35], v[132:135]
    v_perm_b32 v112, v22, v18, s42
    v_perm_b32 v113, v30, v26, s42
    v_mfma_f32_16x16x32_bf16 v[164:167], v[116:119], a[36:39], v[164:167]
    v_perm_b32 v114, v38, v34, s42
    v_perm_b32 v115, v46, v42, s42
    v_mfma_f32_16x16x32_bf16 v[196:199], v[116:119], a[40:43], v[196:199]
    v_mfma_f32_16x16x32_bf16 v[228:231], v[116:119], a[44:47], v[228:231]
    v_mfma_f32_16x16x32_bf16 a[12:15], v[116:119], a[48:51], a[12:15]
    ds_read_b128 a[64:67], v4 offset:12288
    v_mfma_f32_16x16x32_bf16 v[136:139], v[112:115], a[32:35], v[136:139]
    v_perm_b32 v116, v22, v18, s43
    v_perm_b32 v117, v30, v26, s43
    v_mfma_f32_16x16x32_bf16 v[168:171], v[112:115], a[36:39], v[168:171]
    v_perm_b32 v118, v38, v34, s43
    v_perm_b32 v119, v46, v42, s43
    v_mfma_f32_16x16x32_bf16 v[200:203], v[112:115], a[40:43], v[200:203]
    v_mfma_f32_16x16x32_bf16 v[232:235], v[112:115], a[44:47], v[232:235]
    v_mfma_f32_16x16x32_bf16 a[16:19], v[112:115], a[48:51], a[16:19]
    ds_read_b128 a[68:71], v4 offset:16384
    v_mfma_f32_16x16x32_bf16 v[140:143], v[116:119], a[32:35], v[140:143]
    v_perm_b32 v112, v23, v19, s42
    v_perm_b32 v113, v31, v27, s42
    v_mfma_f32_16x16x32_bf16 v[172:175], v[116:119], a[36:39], v[172:175]
    v_perm_b32 v114, v39, v35, s42
    v_perm_b32 v115, v47, v43, s42
    v_mfma_f32_16x16x32_bf16 v[204:207], v[116:119], a[40:43], v[204:207]
    v_mfma_f32_16x16x32_bf16 v[236:239], v[116:119], a[44:47], v[236:239]
    v_mfma_f32_16x16x32_bf16 a[20:23], v[116:119], a[48:51], a[20:23]
    v_mfma_f32_16x16x32_bf16 v[144:147], v[112:115], a[32:35], v[144:147]
    v_perm_b32 v116, v23, v19, s43
    v_perm_b32 v117, v31, v27, s43
    v_mfma_f32_16x16x32_bf16 v[176:179], v[112:115], a[36:39], v[176:179]
    v_perm_b32 v118, v39, v35, s43
    v_perm_b32 v119, v47, v43, s43
    v_mfma_f32_16x16x32_bf16 v[208:211], v[112:115], a[40:43], v[208:211]
    v_mfma_f32_16x16x32_bf16 v[240:243], v[112:115], a[44:47], v[240:243]
    v_mfma_f32_16x16x32_bf16 a[24:27], v[112:115], a[48:51], a[24:27]
    v_mfma_f32_16x16x32_bf16 v[148:151], v[116:119], a[32:35], v[148:151]
    s_waitcnt vmcnt(8)
    s_nop 0
    v_perm_b32 v112, v52, v48, s42
    v_perm_b32 v113, v60, v56, s42
    v_mfma_f32_16x16x32_bf16 v[180:183], v[116:119], a[36:39], v[180:183]
    v_perm_b32 v114, v68, v64, s42
    v_perm_b32 v115, v76, v72, s42
    v_mfma_f32_16x16x32_bf16 v[212:215], v[116:119], a[40:43], v[212:215]
    s_xor_b32 s51, s52, 360448
    buffer_load_dwordx4 v[16:19], v8, s[20:23], s51 offen
    v_mfma_f32_16x16x32_bf16 v[244:247], v[116:119], a[44:47], v[244:247]
    buffer_load_dwordx4 v[20:23], v8, s[20:23], s51 offen offset:1024
    v_mfma_f32_16x16x32_bf16 a[28:31], v[116:119], a[48:51], a[28:31]
    s_waitcnt lgkmcnt(0)
    s_nop 0
    v_mfma_f32_16x16x32_bf16 v[120:123], v[112:115], a[52:55], v[120:123]
    v_perm_b32 v116, v52, v48, s43
    v_perm_b32 v117, v60, v56, s43
    v_mfma_f32_16x16x32_bf16 v[152:155], v[112:115], a[56:59], v[152:155]
    v_perm_b32 v118, v68, v64, s43
    v_perm_b32 v119, v76, v72, s43
    v_mfma_f32_16x16x32_bf16 v[184:187], v[112:115], a[60:63], v[184:187]
    buffer_load_dwordx4 v[24:27], v8, s[20:23], s51 offen offset:2048
    v_mfma_f32_16x16x32_bf16 v[216:219], v[112:115], a[64:67], v[216:219]
    buffer_load_dwordx4 v[28:31], v8, s[20:23], s51 offen offset:3072
    v_mfma_f32_16x16x32_bf16 a[0:3], v[112:115], a[68:71], a[0:3]
    v_xor_b32 v4, 41088, v3
    ds_read_b128 a[32:35], v4
    v_mfma_f32_16x16x32_bf16 v[124:127], v[116:119], a[52:55], v[124:127]
    v_perm_b32 v112, v53, v49, s42
    v_perm_b32 v113, v61, v57, s42
    v_mfma_f32_16x16x32_bf16 v[156:159], v[116:119], a[56:59], v[156:159]
    v_perm_b32 v114, v69, v65, s42
    v_perm_b32 v115, v77, v73, s42
    v_mfma_f32_16x16x32_bf16 v[188:191], v[116:119], a[60:63], v[188:191]
    buffer_load_dwordx4 v[32:35], v9, s[20:23], s51 offen
    v_mfma_f32_16x16x32_bf16 v[220:223], v[116:119], a[64:67], v[220:223]
    buffer_load_dwordx4 v[36:39], v9, s[20:23], s51 offen offset:1024
    v_mfma_f32_16x16x32_bf16 a[4:7], v[116:119], a[68:71], a[4:7]
    ds_read_b128 a[36:39], v4 offset:4096
    v_mfma_f32_16x16x32_bf16 v[128:131], v[112:115], a[52:55], v[128:131]
    v_perm_b32 v116, v53, v49, s43
    v_perm_b32 v117, v61, v57, s43
    v_mfma_f32_16x16x32_bf16 v[160:163], v[112:115], a[56:59], v[160:163]
    v_perm_b32 v118, v69, v65, s43
    v_perm_b32 v119, v77, v73, s43
    v_mfma_f32_16x16x32_bf16 v[192:195], v[112:115], a[60:63], v[192:195]
    buffer_load_dwordx4 v[40:43], v9, s[20:23], s51 offen offset:2048
    v_mfma_f32_16x16x32_bf16 v[224:227], v[112:115], a[64:67], v[224:227]
    buffer_load_dwordx4 v[44:47], v9, s[20:23], s51 offen offset:3072
    v_mfma_f32_16x16x32_bf16 a[8:11], v[112:115], a[68:71], a[8:11]
    ds_read_b128 a[40:43], v4 offset:8192
    v_mfma_f32_16x16x32_bf16 v[132:135], v[116:119], a[52:55], v[132:135]
    v_perm_b32 v112, v54, v50, s42
    v_perm_b32 v113, v62, v58, s42
    v_mfma_f32_16x16x32_bf16 v[164:167], v[116:119], a[56:59], v[164:167]
    v_perm_b32 v114, v70, v66, s42
    v_perm_b32 v115, v78, v74, s42
    v_mfma_f32_16x16x32_bf16 v[196:199], v[116:119], a[60:63], v[196:199]
    v_mfma_f32_16x16x32_bf16 v[228:231], v[116:119], a[64:67], v[228:231]
    v_mfma_f32_16x16x32_bf16 a[12:15], v[116:119], a[68:71], a[12:15]
    ds_read_b128 a[44:47], v4 offset:12288
    v_mfma_f32_16x16x32_bf16 v[136:139], v[112:115], a[52:55], v[136:139]
    v_perm_b32 v116, v54, v50, s43
    v_perm_b32 v117, v62, v58, s43
    v_mfma_f32_16x16x32_bf16 v[168:171], v[112:115], a[56:59], v[168:171]
    v_perm_b32 v118, v70, v66, s43
    v_perm_b32 v119, v78, v74, s43
    v_mfma_f32_16x16x32_bf16 v[200:203], v[112:115], a[60:63], v[200:203]
    v_mfma_f32_16x16x32_bf16 v[232:235], v[112:115], a[64:67], v[232:235]
    v_mfma_f32_16x16x32_bf16 a[16:19], v[112:115], a[68:71], a[16:19]
    ds_read_b128 a[48:51], v4 offset:16384
    v_mfma_f32_16x16x32_bf16 v[140:143], v[116:119], a[52:55], v[140:143]
    v_perm_b32 v112, v55, v51, s42
    v_perm_b32 v113, v63, v59, s42
    v_mfma_f32_16x16x32_bf16 v[172:175], v[116:119], a[56:59], v[172:175]
    v_perm_b32 v114, v71, v67, s42
    v_perm_b32 v115, v79, v75, s42
    v_mfma_f32_16x16x32_bf16 v[204:207], v[116:119], a[60:63], v[204:207]
    v_mfma_f32_16x16x32_bf16 v[236:239], v[116:119], a[64:67], v[236:239]
    v_mfma_f32_16x16x32_bf16 a[20:23], v[116:119], a[68:71], a[20:23]
    v_mfma_f32_16x16x32_bf16 v[144:147], v[112:115], a[52:55], v[144:147]
    v_perm_b32 v116, v55, v51, s43
    v_perm_b32 v117, v63, v59, s43
    v_mfma_f32_16x16x32_bf16 v[176:179], v[112:115], a[56:59], v[176:179]
    v_perm_b32 v118, v71, v67, s43
    v_perm_b32 v119, v79, v75, s43
    v_mfma_f32_16x16x32_bf16 v[208:211], v[112:115], a[60:63], v[208:211]
    v_mfma_f32_16x16x32_bf16 v[240:243], v[112:115], a[64:67], v[240:243]
    v_mfma_f32_16x16x32_bf16 a[24:27], v[112:115], a[68:71], a[24:27]
    v_mfma_f32_16x16x32_bf16 v[148:151], v[116:119], a[52:55], v[148:151]
    s_waitcnt vmcnt(8)
    s_nop 0
    v_perm_b32 v112, v84, v80, s42
    v_perm_b32 v113, v92, v88, s42
    v_mfma_f32_16x16x32_bf16 v[180:183], v[116:119], a[56:59], v[180:183]
    v_perm_b32 v114, v100, v96, s42
    v_perm_b32 v115, v108, v104, s42
    v_mfma_f32_16x16x32_bf16 v[212:215], v[116:119], a[60:63], v[212:215]
    s_xor_b32 s51, s52, 393216
    buffer_load_dwordx4 v[48:51], v8, s[20:23], s51 offen
    v_mfma_f32_16x16x32_bf16 v[244:247], v[116:119], a[64:67], v[244:247]
    buffer_load_dwordx4 v[52:55], v8, s[20:23], s51 offen offset:1024
    v_mfma_f32_16x16x32_bf16 a[28:31], v[116:119], a[68:71], a[28:31]
    s_waitcnt lgkmcnt(0)
    s_nop 0
    v_mfma_f32_16x16x32_bf16 v[120:123], v[112:115], a[32:35], v[120:123]
    v_perm_b32 v116, v84, v80, s43
    v_perm_b32 v117, v92, v88, s43
    v_mfma_f32_16x16x32_bf16 v[152:155], v[112:115], a[36:39], v[152:155]
    v_perm_b32 v118, v100, v96, s43
    v_perm_b32 v119, v108, v104, s43
    v_mfma_f32_16x16x32_bf16 v[184:187], v[112:115], a[40:43], v[184:187]
    buffer_load_dwordx4 v[56:59], v8, s[20:23], s51 offen offset:2048
    v_mfma_f32_16x16x32_bf16 v[216:219], v[112:115], a[44:47], v[216:219]
    buffer_load_dwordx4 v[60:63], v8, s[20:23], s51 offen offset:3072
    v_mfma_f32_16x16x32_bf16 a[0:3], v[112:115], a[48:51], a[0:3]
    v_xor_b32 v4, 41152, v3
    ds_read_b128 a[52:55], v4
    v_mfma_f32_16x16x32_bf16 v[124:127], v[116:119], a[32:35], v[124:127]
    v_perm_b32 v112, v85, v81, s42
    v_perm_b32 v113, v93, v89, s42
    v_mfma_f32_16x16x32_bf16 v[156:159], v[116:119], a[36:39], v[156:159]
    v_perm_b32 v114, v101, v97, s42
    v_perm_b32 v115, v109, v105, s42
    v_mfma_f32_16x16x32_bf16 v[188:191], v[116:119], a[40:43], v[188:191]
    buffer_load_dwordx4 v[64:67], v9, s[20:23], s51 offen
    v_mfma_f32_16x16x32_bf16 v[220:223], v[116:119], a[44:47], v[220:223]
    buffer_load_dwordx4 v[68:71], v9, s[20:23], s51 offen offset:1024
    v_mfma_f32_16x16x32_bf16 a[4:7], v[116:119], a[48:51], a[4:7]
    ds_read_b128 a[56:59], v4 offset:4096
    v_mfma_f32_16x16x32_bf16 v[128:131], v[112:115], a[32:35], v[128:131]
    v_perm_b32 v116, v85, v81, s43
    v_perm_b32 v117, v93, v89, s43
    v_mfma_f32_16x16x32_bf16 v[160:163], v[112:115], a[36:39], v[160:163]
    v_perm_b32 v118, v101, v97, s43
    v_perm_b32 v119, v109, v105, s43
    v_mfma_f32_16x16x32_bf16 v[192:195], v[112:115], a[40:43], v[192:195]
    buffer_load_dwordx4 v[72:75], v9, s[20:23], s51 offen offset:2048
    v_mfma_f32_16x16x32_bf16 v[224:227], v[112:115], a[44:47], v[224:227]
    buffer_load_dwordx4 v[76:79], v9, s[20:23], s51 offen offset:3072
    v_mfma_f32_16x16x32_bf16 a[8:11], v[112:115], a[48:51], a[8:11]
    ds_read_b128 a[60:63], v4 offset:8192
    v_mfma_f32_16x16x32_bf16 v[132:135], v[116:119], a[32:35], v[132:135]
    v_perm_b32 v112, v86, v82, s42
    v_perm_b32 v113, v94, v90, s42
    v_mfma_f32_16x16x32_bf16 v[164:167], v[116:119], a[36:39], v[164:167]
    v_perm_b32 v114, v102, v98, s42
    v_perm_b32 v115, v110, v106, s42
    v_mfma_f32_16x16x32_bf16 v[196:199], v[116:119], a[40:43], v[196:199]
    v_mfma_f32_16x16x32_bf16 v[228:231], v[116:119], a[44:47], v[228:231]
    v_mfma_f32_16x16x32_bf16 a[12:15], v[116:119], a[48:51], a[12:15]
    ds_read_b128 a[64:67], v4 offset:12288
    v_mfma_f32_16x16x32_bf16 v[136:139], v[112:115], a[32:35], v[136:139]
    v_perm_b32 v116, v86, v82, s43
    v_perm_b32 v117, v94, v90, s43
    v_mfma_f32_16x16x32_bf16 v[168:171], v[112:115], a[36:39], v[168:171]
    v_perm_b32 v118, v102, v98, s43
    v_perm_b32 v119, v110, v106, s43
    v_mfma_f32_16x16x32_bf16 v[200:203], v[112:115], a[40:43], v[200:203]
    v_mfma_f32_16x16x32_bf16 v[232:235], v[112:115], a[44:47], v[232:235]
    v_mfma_f32_16x16x32_bf16 a[16:19], v[112:115], a[48:51], a[16:19]
    ds_read_b128 a[68:71], v4 offset:16384
    v_mfma_f32_16x16x32_bf16 v[140:143], v[116:119], a[32:35], v[140:143]
    v_perm_b32 v112, v87, v83, s42
    v_perm_b32 v113, v95, v91, s42
    v_mfma_f32_16x16x32_bf16 v[172:175], v[116:119], a[36:39], v[172:175]
    v_perm_b32 v114, v103, v99, s42
    v_perm_b32 v115, v111, v107, s42
    v_mfma_f32_16x16x32_bf16 v[204:207], v[116:119], a[40:43], v[204:207]
    v_mfma_f32_16x16x32_bf16 v[236:239], v[116:119], a[44:47], v[236:239]
    v_mfma_f32_16x16x32_bf16 a[20:23], v[116:119], a[48:51], a[20:23]
    v_mfma_f32_16x16x32_bf16 v[144:147], v[112:115], a[32:35], v[144:147]
    v_perm_b32 v116, v87, v83, s43
    v_perm_b32 v117, v95, v91, s43
    v_mfma_f32_16x16x32_bf16 v[176:179], v[112:115], a[36:39], v[176:179]
    v_perm_b32 v118, v103, v99, s43
    v_perm_b32 v119, v111, v107, s43
    v_mfma_f32_16x16x32_bf16 v[208:211], v[112:115], a[40:43], v[208:211]
    v_mfma_f32_16x16x32_bf16 v[240:243], v[112:115], a[44:47], v[240:243]
    v_mfma_f32_16x16x32_bf16 a[24:27], v[112:115], a[48:51], a[24:27]
    v_mfma_f32_16x16x32_bf16 v[148:151], v[116:119], a[32:35], v[148:151]
    s_waitcnt vmcnt(8)
    s_nop 0
    v_perm_b32 v112, v20, v16, s42
    v_perm_b32 v113, v28, v24, s42
    v_mfma_f32_16x16x32_bf16 v[180:183], v[116:119], a[36:39], v[180:183]
    v_perm_b32 v114, v36, v32, s42
    v_perm_b32 v115, v44, v40, s42
    v_mfma_f32_16x16x32_bf16 v[212:215], v[116:119], a[40:43], v[212:215]
    s_xor_b32 s51, s52, 425984
    buffer_load_dwordx4 v[80:83], v8, s[20:23], s51 offen
    v_mfma_f32_16x16x32_bf16 v[244:247], v[116:119], a[44:47], v[244:247]
    buffer_load_dwordx4 v[84:87], v8, s[20:23], s51 offen offset:1024
    v_mfma_f32_16x16x32_bf16 a[28:31], v[116:119], a[48:51], a[28:31]
    s_waitcnt lgkmcnt(0)
    s_nop 0
    v_mfma_f32_16x16x32_bf16 v[120:123], v[112:115], a[52:55], v[120:123]
    v_perm_b32 v116, v20, v16, s43
    v_perm_b32 v117, v28, v24, s43
    v_mfma_f32_16x16x32_bf16 v[152:155], v[112:115], a[56:59], v[152:155]
    v_perm_b32 v118, v36, v32, s43
    v_perm_b32 v119, v44, v40, s43
    v_mfma_f32_16x16x32_bf16 v[184:187], v[112:115], a[60:63], v[184:187]
    buffer_load_dwordx4 v[88:91], v8, s[20:23], s51 offen offset:2048
    v_mfma_f32_16x16x32_bf16 v[216:219], v[112:115], a[64:67], v[216:219]
    buffer_load_dwordx4 v[92:95], v8, s[20:23], s51 offen offset:3072
    v_mfma_f32_16x16x32_bf16 a[0:3], v[112:115], a[68:71], a[0:3]
    v_xor_b32 v4, 61440, v3
    ds_read_b128 a[32:35], v4
    v_mfma_f32_16x16x32_bf16 v[124:127], v[116:119], a[52:55], v[124:127]
    v_perm_b32 v112, v21, v17, s42
    v_perm_b32 v113, v29, v25, s42
    v_mfma_f32_16x16x32_bf16 v[156:159], v[116:119], a[56:59], v[156:159]
    v_perm_b32 v114, v37, v33, s42
    v_perm_b32 v115, v45, v41, s42
    v_mfma_f32_16x16x32_bf16 v[188:191], v[116:119], a[60:63], v[188:191]
    buffer_load_dwordx4 v[96:99], v9, s[20:23], s51 offen
    v_mfma_f32_16x16x32_bf16 v[220:223], v[116:119], a[64:67], v[220:223]
    buffer_load_dwordx4 v[100:103], v9, s[20:23], s51 offen offset:1024
    v_mfma_f32_16x16x32_bf16 a[4:7], v[116:119], a[68:71], a[4:7]
    ds_read_b128 a[36:39], v4 offset:4096
    v_mfma_f32_16x16x32_bf16 v[128:131], v[112:115], a[52:55], v[128:131]
    v_perm_b32 v116, v21, v17, s43
    v_perm_b32 v117, v29, v25, s43
    v_mfma_f32_16x16x32_bf16 v[160:163], v[112:115], a[56:59], v[160:163]
    v_perm_b32 v118, v37, v33, s43
    v_perm_b32 v119, v45, v41, s43
    v_mfma_f32_16x16x32_bf16 v[192:195], v[112:115], a[60:63], v[192:195]
    buffer_load_dwordx4 v[104:107], v9, s[20:23], s51 offen offset:2048
    v_mfma_f32_16x16x32_bf16 v[224:227], v[112:115], a[64:67], v[224:227]
    buffer_load_dwordx4 v[108:111], v9, s[20:23], s51 offen offset:3072
    v_mfma_f32_16x16x32_bf16 a[8:11], v[112:115], a[68:71], a[8:11]
    ds_read_b128 a[40:43], v4 offset:8192
    v_mfma_f32_16x16x32_bf16 v[132:135], v[116:119], a[52:55], v[132:135]
    v_perm_b32 v112, v22, v18, s42
    v_perm_b32 v113, v30, v26, s42
    v_mfma_f32_16x16x32_bf16 v[164:167], v[116:119], a[56:59], v[164:167]
    v_perm_b32 v114, v38, v34, s42
    v_perm_b32 v115, v46, v42, s42
    v_mfma_f32_16x16x32_bf16 v[196:199], v[116:119], a[60:63], v[196:199]
    v_mfma_f32_16x16x32_bf16 v[228:231], v[116:119], a[64:67], v[228:231]
    v_mfma_f32_16x16x32_bf16 a[12:15], v[116:119], a[68:71], a[12:15]
    ds_read_b128 a[44:47], v4 offset:12288
    v_mfma_f32_16x16x32_bf16 v[136:139], v[112:115], a[52:55], v[136:139]
    v_perm_b32 v116, v22, v18, s43
    v_perm_b32 v117, v30, v26, s43
    v_mfma_f32_16x16x32_bf16 v[168:171], v[112:115], a[56:59], v[168:171]
    v_perm_b32 v118, v38, v34, s43
    v_perm_b32 v119, v46, v42, s43
    v_mfma_f32_16x16x32_bf16 v[200:203], v[112:115], a[60:63], v[200:203]
    v_mfma_f32_16x16x32_bf16 v[232:235], v[112:115], a[64:67], v[232:235]
    v_mfma_f32_16x16x32_bf16 a[16:19], v[112:115], a[68:71], a[16:19]
    ds_read_b128 a[48:51], v4 offset:16384
    v_mfma_f32_16x16x32_bf16 v[140:143], v[116:119], a[52:55], v[140:143]
    v_perm_b32 v112, v23, v19, s42
    v_perm_b32 v113, v31, v27, s42
    v_mfma_f32_16x16x32_bf16 v[172:175], v[116:119], a[56:59], v[172:175]
    v_perm_b32 v114, v39, v35, s42
    v_perm_b32 v115, v47, v43, s42
    v_mfma_f32_16x16x32_bf16 v[204:207], v[116:119], a[60:63], v[204:207]
    v_mfma_f32_16x16x32_bf16 v[236:239], v[116:119], a[64:67], v[236:239]
    v_mfma_f32_16x16x32_bf16 a[20:23], v[116:119], a[68:71], a[20:23]
    v_mfma_f32_16x16x32_bf16 v[144:147], v[112:115], a[52:55], v[144:147]
    v_perm_b32 v116, v23, v19, s43
    v_perm_b32 v117, v31, v27, s43
    v_mfma_f32_16x16x32_bf16 v[176:179], v[112:115], a[56:59], v[176:179]
    v_perm_b32 v118, v39, v35, s43
    v_perm_b32 v119, v47, v43, s43
    v_mfma_f32_16x16x32_bf16 v[208:211], v[112:115], a[60:63], v[208:211]
    v_mfma_f32_16x16x32_bf16 v[240:243], v[112:115], a[64:67], v[240:243]
    v_mfma_f32_16x16x32_bf16 a[24:27], v[112:115], a[68:71], a[24:27]
    v_mfma_f32_16x16x32_bf16 v[148:151], v[116:119], a[52:55], v[148:151]
    s_waitcnt vmcnt(8)
    s_nop 0
    v_perm_b32 v112, v52, v48, s42
    v_perm_b32 v113, v60, v56, s42
    v_mfma_f32_16x16x32_bf16 v[180:183], v[116:119], a[56:59], v[180:183]
    v_perm_b32 v114, v68, v64, s42
    v_perm_b32 v115, v76, v72, s42
    v_mfma_f32_16x16x32_bf16 v[212:215], v[116:119], a[60:63], v[212:215]
    s_xor_b32 s51, s52, 458752
    buffer_load_dwordx4 v[16:19], v8, s[20:23], s51 offen
    v_mfma_f32_16x16x32_bf16 v[244:247], v[116:119], a[64:67], v[244:247]
    buffer_load_dwordx4 v[20:23], v8, s[20:23], s51 offen offset:1024
    v_mfma_f32_16x16x32_bf16 a[28:31], v[116:119], a[68:71], a[28:31]
    s_waitcnt lgkmcnt(0)
    s_nop 0
    v_mfma_f32_16x16x32_bf16 v[120:123], v[112:115], a[32:35], v[120:123]
    v_perm_b32 v116, v52, v48, s43
    v_perm_b32 v117, v60, v56, s43
    v_mfma_f32_16x16x32_bf16 v[152:155], v[112:115], a[36:39], v[152:155]
    v_perm_b32 v118, v68, v64, s43
    v_perm_b32 v119, v76, v72, s43
    v_mfma_f32_16x16x32_bf16 v[184:187], v[112:115], a[40:43], v[184:187]
    buffer_load_dwordx4 v[24:27], v8, s[20:23], s51 offen offset:2048
    v_mfma_f32_16x16x32_bf16 v[216:219], v[112:115], a[44:47], v[216:219]
    buffer_load_dwordx4 v[28:31], v8, s[20:23], s51 offen offset:3072
    v_mfma_f32_16x16x32_bf16 a[0:3], v[112:115], a[48:51], a[0:3]
    v_xor_b32 v4, 61504, v3
    ds_read_b128 a[52:55], v4
    v_mfma_f32_16x16x32_bf16 v[124:127], v[116:119], a[32:35], v[124:127]
    v_perm_b32 v112, v53, v49, s42
    v_perm_b32 v113, v61, v57, s42
    v_mfma_f32_16x16x32_bf16 v[156:159], v[116:119], a[36:39], v[156:159]
    v_perm_b32 v114, v69, v65, s42
    v_perm_b32 v115, v77, v73, s42
    v_mfma_f32_16x16x32_bf16 v[188:191], v[116:119], a[40:43], v[188:191]
    buffer_load_dwordx4 v[32:35], v9, s[20:23], s51 offen
    v_mfma_f32_16x16x32_bf16 v[220:223], v[116:119], a[44:47], v[220:223]
    buffer_load_dwordx4 v[36:39], v9, s[20:23], s51 offen offset:1024
    v_mfma_f32_16x16x32_bf16 a[4:7], v[116:119], a[48:51], a[4:7]
    ds_read_b128 a[56:59], v4 offset:4096
    v_mfma_f32_16x16x32_bf16 v[128:131], v[112:115], a[32:35], v[128:131]
    v_perm_b32 v116, v53, v49, s43
    v_perm_b32 v117, v61, v57, s43
    v_mfma_f32_16x16x32_bf16 v[160:163], v[112:115], a[36:39], v[160:163]
    v_perm_b32 v118, v69, v65, s43
    v_perm_b32 v119, v77, v73, s43
    v_mfma_f32_16x16x32_bf16 v[192:195], v[112:115], a[40:43], v[192:195]
    buffer_load_dwordx4 v[40:43], v9, s[20:23], s51 offen offset:2048
    v_mfma_f32_16x16x32_bf16 v[224:227], v[112:115], a[44:47], v[224:227]
    buffer_load_dwordx4 v[44:47], v9, s[20:23], s51 offen offset:3072
    v_mfma_f32_16x16x32_bf16 a[8:11], v[112:115], a[48:51], a[8:11]
    ds_read_b128 a[60:63], v4 offset:8192
    v_mfma_f32_16x16x32_bf16 v[132:135], v[116:119], a[32:35], v[132:135]
    v_perm_b32 v112, v54, v50, s42
    v_perm_b32 v113, v62, v58, s42
    v_mfma_f32_16x16x32_bf16 v[164:167], v[116:119], a[36:39], v[164:167]
    v_perm_b32 v114, v70, v66, s42
    v_perm_b32 v115, v78, v74, s42
    v_mfma_f32_16x16x32_bf16 v[196:199], v[116:119], a[40:43], v[196:199]
    v_mfma_f32_16x16x32_bf16 v[228:231], v[116:119], a[44:47], v[228:231]
    v_mfma_f32_16x16x32_bf16 a[12:15], v[116:119], a[48:51], a[12:15]
    ds_read_b128 a[64:67], v4 offset:12288
    v_mfma_f32_16x16x32_bf16 v[136:139], v[112:115], a[32:35], v[136:139]
    v_perm_b32 v116, v54, v50, s43
    v_perm_b32 v117, v62, v58, s43
    v_mfma_f32_16x16x32_bf16 v[168:171], v[112:115], a[36:39], v[168:171]
    v_perm_b32 v118, v70, v66, s43
    v_perm_b32 v119, v78, v74, s43
    v_mfma_f32_16x16x32_bf16 v[200:203], v[112:115], a[40:43], v[200:203]
    v_mfma_f32_16x16x32_bf16 v[232:235], v[112:115], a[44:47], v[232:235]
    v_mfma_f32_16x16x32_bf16 a[16:19], v[112:115], a[48:51], a[16:19]
    ds_read_b128 a[68:71], v4 offset:16384
    v_mfma_f32_16x16x32_bf16 v[140:143], v[116:119], a[32:35], v[140:143]
    v_perm_b32 v112, v55, v51, s42
    v_perm_b32 v113, v63, v59, s42
    v_mfma_f32_16x16x32_bf16 v[172:175], v[116:119], a[36:39], v[172:175]
    v_perm_b32 v114, v71, v67, s42
    v_perm_b32 v115, v79, v75, s42
    v_mfma_f32_16x16x32_bf16 v[204:207], v[116:119], a[40:43], v[204:207]
    v_mfma_f32_16x16x32_bf16 v[236:239], v[116:119], a[44:47], v[236:239]
    v_mfma_f32_16x16x32_bf16 a[20:23], v[116:119], a[48:51], a[20:23]
    v_mfma_f32_16x16x32_bf16 v[144:147], v[112:115], a[32:35], v[144:147]
    v_perm_b32 v116, v55, v51, s43
    v_perm_b32 v117, v63, v59, s43
    v_mfma_f32_16x16x32_bf16 v[176:179], v[112:115], a[36:39], v[176:179]
    v_perm_b32 v118, v71, v67, s43
    v_perm_b32 v119, v79, v75, s43
    v_mfma_f32_16x16x32_bf16 v[208:211], v[112:115], a[40:43], v[208:211]
    v_mfma_f32_16x16x32_bf16 v[240:243], v[112:115], a[44:47], v[240:243]
    v_mfma_f32_16x16x32_bf16 a[24:27], v[112:115], a[48:51], a[24:27]
    v_mfma_f32_16x16x32_bf16 v[148:151], v[116:119], a[32:35], v[148:151]
    s_waitcnt vmcnt(8)
    s_nop 0
    v_perm_b32 v112, v84, v80, s42
    v_perm_b32 v113, v92, v88, s42
    v_mfma_f32_16x16x32_bf16 v[180:183], v[116:119], a[36:39], v[180:183]
    v_perm_b32 v114, v100, v96, s42
    v_perm_b32 v115, v108, v104, s42
    v_mfma_f32_16x16x32_bf16 v[212:215], v[116:119], a[40:43], v[212:215]
    s_xor_b32 s51, s52, 491520
    buffer_load_dwordx4 v[48:51], v8, s[20:23], s51 offen
    v_mfma_f32_16x16x32_bf16 v[244:247], v[116:119], a[44:47], v[244:247]
    buffer_load_dwordx4 v[52:55], v8, s[20:23], s51 offen offset:1024
    v_mfma_f32_16x16x32_bf16 a[28:31], v[116:119], a[48:51], a[28:31]
    s_waitcnt lgkmcnt(0)
    s_nop 0
    v_mfma_f32_16x16x32_bf16 v[120:123], v[112:115], a[52:55], v[120:123]
    v_perm_b32 v116, v84, v80, s43
    v_perm_b32 v117, v92, v88, s43
    v_mfma_f32_16x16x32_bf16 v[152:155], v[112:115], a[56:59], v[152:155]
    v_perm_b32 v118, v100, v96, s43
    v_perm_b32 v119, v108, v104, s43
    v_mfma_f32_16x16x32_bf16 v[184:187], v[112:115], a[60:63], v[184:187]
    buffer_load_dwordx4 v[56:59], v8, s[20:23], s51 offen offset:2048
    v_mfma_f32_16x16x32_bf16 v[216:219], v[112:115], a[64:67], v[216:219]
    buffer_load_dwordx4 v[60:63], v8, s[20:23], s51 offen offset:3072
    v_mfma_f32_16x16x32_bf16 a[0:3], v[112:115], a[68:71], a[0:3]
    v_xor_b32 v4, 61568, v3
    ds_read_b128 a[32:35], v4
    v_mfma_f32_16x16x32_bf16 v[124:127], v[116:119], a[52:55], v[124:127]
    v_perm_b32 v112, v85, v81, s42
    v_perm_b32 v113, v93, v89, s42
    v_mfma_f32_16x16x32_bf16 v[156:159], v[116:119], a[56:59], v[156:159]
    v_perm_b32 v114, v101, v97, s42
    v_perm_b32 v115, v109, v105, s42
    v_mfma_f32_16x16x32_bf16 v[188:191], v[116:119], a[60:63], v[188:191]
    buffer_load_dwordx4 v[64:67], v9, s[20:23], s51 offen
    v_mfma_f32_16x16x32_bf16 v[220:223], v[116:119], a[64:67], v[220:223]
    buffer_load_dwordx4 v[68:71], v9, s[20:23], s51 offen offset:1024
    v_mfma_f32_16x16x32_bf16 a[4:7], v[116:119], a[68:71], a[4:7]
    ds_read_b128 a[36:39], v4 offset:4096
    v_mfma_f32_16x16x32_bf16 v[128:131], v[112:115], a[52:55], v[128:131]
    v_perm_b32 v116, v85, v81, s43
    v_perm_b32 v117, v93, v89, s43
    v_mfma_f32_16x16x32_bf16 v[160:163], v[112:115], a[56:59], v[160:163]
    v_perm_b32 v118, v101, v97, s43
    v_perm_b32 v119, v109, v105, s43
    v_mfma_f32_16x16x32_bf16 v[192:195], v[112:115], a[60:63], v[192:195]
    buffer_load_dwordx4 v[72:75], v9, s[20:23], s51 offen offset:2048
    v_mfma_f32_16x16x32_bf16 v[224:227], v[112:115], a[64:67], v[224:227]
    buffer_load_dwordx4 v[76:79], v9, s[20:23], s51 offen offset:3072
    v_mfma_f32_16x16x32_bf16 a[8:11], v[112:115], a[68:71], a[8:11]
    ds_read_b128 a[40:43], v4 offset:8192
    v_mfma_f32_16x16x32_bf16 v[132:135], v[116:119], a[52:55], v[132:135]
    v_perm_b32 v112, v86, v82, s42
    v_perm_b32 v113, v94, v90, s42
    v_mfma_f32_16x16x32_bf16 v[164:167], v[116:119], a[56:59], v[164:167]
    v_perm_b32 v114, v102, v98, s42
    v_perm_b32 v115, v110, v106, s42
    v_mfma_f32_16x16x32_bf16 v[196:199], v[116:119], a[60:63], v[196:199]
    v_mfma_f32_16x16x32_bf16 v[228:231], v[116:119], a[64:67], v[228:231]
    v_mfma_f32_16x16x32_bf16 a[12:15], v[116:119], a[68:71], a[12:15]
    ds_read_b128 a[44:47], v4 offset:12288
    v_mfma_f32_16x16x32_bf16 v[136:139], v[112:115], a[52:55], v[136:139]
    v_perm_b32 v116, v86, v82, s43
    v_perm_b32 v117, v94, v90, s43
    v_mfma_f32_16x16x32_bf16 v[168:171], v[112:115], a[56:59], v[168:171]
    v_perm_b32 v118, v102, v98, s43
    v_perm_b32 v119, v110, v106, s43
    v_mfma_f32_16x16x32_bf16 v[200:203], v[112:115], a[60:63], v[200:203]
    v_mfma_f32_16x16x32_bf16 v[232:235], v[112:115], a[64:67], v[232:235]
    v_mfma_f32_16x16x32_bf16 a[16:19], v[112:115], a[68:71], a[16:19]
    ds_read_b128 a[48:51], v4 offset:16384
    v_mfma_f32_16x16x32_bf16 v[140:143], v[116:119], a[52:55], v[140:143]
    v_perm_b32 v112, v87, v83, s42
    v_perm_b32 v113, v95, v91, s42
    v_mfma_f32_16x16x32_bf16 v[172:175], v[116:119], a[56:59], v[172:175]
    v_perm_b32 v114, v103, v99, s42
    v_perm_b32 v115, v111, v107, s42
    v_mfma_f32_16x16x32_bf16 v[204:207], v[116:119], a[60:63], v[204:207]
    v_mfma_f32_16x16x32_bf16 v[236:239], v[116:119], a[64:67], v[236:239]
    v_mfma_f32_16x16x32_bf16 a[20:23], v[116:119], a[68:71], a[20:23]
    v_mfma_f32_16x16x32_bf16 v[144:147], v[112:115], a[52:55], v[144:147]
    v_perm_b32 v116, v87, v83, s43
    v_perm_b32 v117, v95, v91, s43
    v_mfma_f32_16x16x32_bf16 v[176:179], v[112:115], a[56:59], v[176:179]
    v_perm_b32 v118, v103, v99, s43
    v_perm_b32 v119, v111, v107, s43
    v_mfma_f32_16x16x32_bf16 v[208:211], v[112:115], a[60:63], v[208:211]
    v_mfma_f32_16x16x32_bf16 v[240:243], v[112:115], a[64:67], v[240:243]
    v_mfma_f32_16x16x32_bf16 a[24:27], v[112:115], a[68:71], a[24:27]
    v_mfma_f32_16x16x32_bf16 v[148:151], v[116:119], a[52:55], v[148:151]
    s_waitcnt vmcnt(8)
    s_nop 0
    v_perm_b32 v80, v20, v16, s42
    v_perm_b32 v81, v28, v24, s42
    v_mfma_f32_16x16x32_bf16 v[180:183], v[116:119], a[56:59], v[180:183]
    v_perm_b32 v82, v36, v32, s42
    v_perm_b32 v83, v44, v40, s42
    v_mfma_f32_16x16x32_bf16 v[212:215], v[116:119], a[60:63], v[212:215]
    v_perm_b32 v84, v20, v16, s43
    v_perm_b32 v85, v28, v24, s43
    v_mfma_f32_16x16x32_bf16 v[244:247], v[116:119], a[64:67], v[244:247]
    v_perm_b32 v86, v36, v32, s43
    v_perm_b32 v87, v44, v40, s43
    v_mfma_f32_16x16x32_bf16 a[28:31], v[116:119], a[68:71], a[28:31]
    v_perm_b32 v88, v21, v17, s42
    v_perm_b32 v89, v29, v25, s42
    s_waitcnt lgkmcnt(0)
    s_nop 0
    v_mfma_f32_16x16x32_bf16 v[120:123], v[80:83], a[32:35], v[120:123]
    v_xor_b32 v4, 61632, v3
    ds_read_b128 a[52:55], v4
    v_mfma_f32_16x16x32_bf16 v[124:127], v[84:87], a[32:35], v[124:127]
    ds_read_b128 a[56:59], v4 offset:4096
    ds_read_b128 a[60:63], v4 offset:8192
    v_mfma_f32_16x16x32_bf16 v[152:155], v[80:83], a[36:39], v[152:155]
    ds_read_b128 a[64:67], v4 offset:12288
    ds_read_b128 a[68:71], v4 offset:16384
    v_mfma_f32_16x16x32_bf16 v[156:159], v[84:87], a[36:39], v[156:159]
    v_perm_b32 v90, v37, v33, s42
    v_perm_b32 v91, v45, v41, s42
    v_mfma_f32_16x16x32_bf16 v[184:187], v[80:83], a[40:43], v[184:187]
    v_perm_b32 v92, v21, v17, s43
    v_perm_b32 v93, v29, v25, s43
    v_mfma_f32_16x16x32_bf16 v[128:131], v[88:91], a[32:35], v[128:131]
    v_perm_b32 v94, v37, v33, s43
    v_perm_b32 v95, v45, v41, s43
    v_mfma_f32_16x16x32_bf16 v[160:163], v[88:91], a[36:39], v[160:163]
    v_perm_b32 v96, v22, v18, s42
    v_perm_b32 v97, v30, v26, s42
    v_mfma_f32_16x16x32_bf16 v[132:135], v[92:95], a[32:35], v[132:135]
    v_perm_b32 v98, v38, v34, s42
    v_perm_b32 v99, v46, v42, s42
    v_mfma_f32_16x16x32_bf16 v[164:167], v[92:95], a[36:39], v[164:167]
    v_perm_b32 v100, v22, v18, s43
    v_perm_b32 v101, v30, v26, s43
    v_mfma_f32_16x16x32_bf16 v[136:139], v[96:99], a[32:35], v[136:139]
    v_perm_b32 v102, v38, v34, s43
    v_perm_b32 v103, v46, v42, s43
    v_mfma_f32_16x16x32_bf16 v[168:171], v[96:99], a[36:39], v[168:171]
    v_perm_b32 v104, v23, v19, s42
    v_perm_b32 v105, v31, v27, s42
    v_mfma_f32_16x16x32_bf16 v[140:143], v[100:103], a[32:35], v[140:143]
    v_perm_b32 v106, v39, v35, s42
    v_perm_b32 v107, v47, v43, s42
    v_mfma_f32_16x16x32_bf16 v[172:175], v[100:103], a[36:39], v[172:175]
    v_perm_b32 v108, v23, v19, s43
    v_perm_b32 v109, v31, v27, s43
    v_mfma_f32_16x16x32_bf16 v[144:147], v[104:107], a[32:35], v[144:147]
    v_perm_b32 v110, v39, v35, s43
    v_perm_b32 v111, v47, v43, s43
    v_mfma_f32_16x16x32_bf16 v[176:179], v[104:107], a[36:39], v[176:179]
    s_waitcnt vmcnt(6)
    s_nop 0
    v_perm_b32 v16, v52, v48, s42
    s_waitcnt vmcnt(4)
    s_nop 0
    v_perm_b32 v17, v60, v56, s42
    v_mfma_f32_16x16x32_bf16 v[148:151], v[108:111], a[32:35], v[148:151]
    s_waitcnt vmcnt(2)
    s_nop 0
    v_perm_b32 v18, v68, v64, s42
    s_waitcnt vmcnt(0)
    s_nop 0
    v_perm_b32 v19, v76, v72, s42
    v_mfma_f32_16x16x32_bf16 v[180:183], v[108:111], a[36:39], v[180:183]
    v_perm_b32 v20, v52, v48, s43
    v_perm_b32 v21, v60, v56, s43
    v_mfma_f32_16x16x32_bf16 v[188:191], v[84:87], a[40:43], v[188:191]
    v_perm_b32 v22, v68, v64, s43
    v_perm_b32 v23, v76, v72, s43
    v_mfma_f32_16x16x32_bf16 a[0:3], v[80:83], a[48:51], a[0:3]
    v_perm_b32 v24, v53, v49, s42
    v_perm_b32 v25, v61, v57, s42
    v_mfma_f32_16x16x32_bf16 a[4:7], v[84:87], a[48:51], a[4:7]
    v_perm_b32 v26, v69, v65, s42
    v_perm_b32 v27, v77, v73, s42
    v_mfma_f32_16x16x32_bf16 a[8:11], v[88:91], a[48:51], a[8:11]
    v_perm_b32 v28, v53, v49, s43
    v_perm_b32 v29, v61, v57, s43
    v_mfma_f32_16x16x32_bf16 a[12:15], v[92:95], a[48:51], a[12:15]
    v_perm_b32 v30, v69, v65, s43
    v_perm_b32 v31, v77, v73, s43
    v_mfma_f32_16x16x32_bf16 a[16:19], v[96:99], a[48:51], a[16:19]
    v_perm_b32 v32, v54, v50, s42
    v_perm_b32 v33, v62, v58, s42
    v_mfma_f32_16x16x32_bf16 a[20:23], v[100:103], a[48:51], a[20:23]
    v_perm_b32 v34, v70, v66, s42
    v_perm_b32 v35, v78, v74, s42
    v_mfma_f32_16x16x32_bf16 a[24:27], v[104:107], a[48:51], a[24:27]
    v_perm_b32 v36, v54, v50, s43
    v_perm_b32 v37, v62, v58, s43
    v_mfma_f32_16x16x32_bf16 a[28:31], v[108:111], a[48:51], a[28:31]
    v_perm_b32 v38, v70, v66, s43
    v_perm_b32 v39, v78, v74, s43
    v_mfma_f32_16x16x32_bf16 v[192:195], v[88:91], a[40:43], v[192:195]
    v_perm_b32 v40, v55, v51, s42
    v_perm_b32 v41, v63, v59, s42
    v_mfma_f32_16x16x32_bf16 v[196:199], v[92:95], a[40:43], v[196:199]
    v_perm_b32 v42, v71, v67, s42
    v_perm_b32 v43, v79, v75, s42
    v_mfma_f32_16x16x32_bf16 v[200:203], v[96:99], a[40:43], v[200:203]
    v_perm_b32 v44, v55, v51, s43
    v_perm_b32 v45, v63, v59, s43
    v_mfma_f32_16x16x32_bf16 v[204:207], v[100:103], a[40:43], v[204:207]
    v_perm_b32 v46, v71, v67, s43
    v_perm_b32 v47, v79, v75, s43
    v_mfma_f32_16x16x32_bf16 v[208:211], v[104:107], a[40:43], v[208:211]
    v_mfma_f32_16x16x32_bf16 v[212:215], v[108:111], a[40:43], v[212:215]
    s_waitcnt lgkmcnt(4)
    s_nop 0
    v_mfma_f32_16x16x32_bf16 v[120:123], v[16:19], a[52:55], v[120:123]
    v_mfma_f32_16x16x32_bf16 v[124:127], v[20:23], a[52:55], v[124:127]
    v_mfma_f32_16x16x32_bf16 v[128:131], v[24:27], a[52:55], v[128:131]
    v_mfma_f32_16x16x32_bf16 v[132:135], v[28:31], a[52:55], v[132:135]
    s_nop 5
    s_nop 0
    v_cvt_pk_bf16_f32 v48, v120, v124
    v_mfma_f32_16x16x32_bf16 v[136:139], v[32:35], a[52:55], v[136:139]
    v_cvt_pk_bf16_f32 v52, v121, v125
    v_cvt_pk_bf16_f32 v56, v122, v126
    v_mfma_f32_16x16x32_bf16 v[140:143], v[36:39], a[52:55], v[140:143]
    v_cvt_pk_bf16_f32 v60, v123, v127
    v_cvt_pk_bf16_f32 v49, v128, v132
    v_mfma_f32_16x16x32_bf16 v[144:147], v[40:43], a[52:55], v[144:147]
    v_cvt_pk_bf16_f32 v53, v129, v133
    v_cvt_pk_bf16_f32 v57, v130, v134
    v_mfma_f32_16x16x32_bf16 v[148:151], v[44:47], a[52:55], v[148:151]
    v_cvt_pk_bf16_f32 v61, v131, v135
    s_nop 0
    s_nop 0
    v_cvt_pk_bf16_f32 v50, v136, v140
    v_mfma_f32_16x16x32_bf16 v[216:219], v[80:83], a[44:47], v[216:219]
    v_cvt_pk_bf16_f32 v54, v137, v141
    v_cvt_pk_bf16_f32 v58, v138, v142
    v_mfma_f32_16x16x32_bf16 v[220:223], v[84:87], a[44:47], v[220:223]
    v_cvt_pk_bf16_f32 v62, v139, v143
    v_cvt_pk_bf16_f32 v51, v144, v148
    v_mfma_f32_16x16x32_bf16 v[224:227], v[88:91], a[44:47], v[224:227]
    buffer_store_dwordx4 v[48:51], v12, s[24:27], s60 offen sc1
    v_cvt_pk_bf16_f32 v55, v145, v149
    v_mfma_f32_16x16x32_bf16 v[228:231], v[92:95], a[44:47], v[228:231]
    buffer_store_dwordx4 v[52:55], v12, s[24:27], s60 offen offset:2048 sc1
    v_cvt_pk_bf16_f32 v59, v146, v150
    v_mfma_f32_16x16x32_bf16 v[232:235], v[96:99], a[44:47], v[232:235]
    buffer_store_dwordx4 v[56:59], v13, s[24:27], s60 offen sc1
    v_cvt_pk_bf16_f32 v63, v147, v151
    v_mfma_f32_16x16x32_bf16 v[236:239], v[100:103], a[44:47], v[236:239]
    buffer_store_dwordx4 v[60:63], v13, s[24:27], s60 offen offset:2048 sc1
    v_mfma_f32_16x16x32_bf16 v[240:243], v[104:107], a[44:47], v[240:243]
    v_mfma_f32_16x16x32_bf16 v[244:247], v[108:111], a[44:47], v[244:247]
    s_waitcnt lgkmcnt(3)
    s_nop 0
    v_mfma_f32_16x16x32_bf16 v[152:155], v[16:19], a[56:59], v[152:155]
    v_mfma_f32_16x16x32_bf16 v[156:159], v[20:23], a[56:59], v[156:159]
    v_mfma_f32_16x16x32_bf16 v[160:163], v[24:27], a[56:59], v[160:163]
    v_mfma_f32_16x16x32_bf16 v[164:167], v[28:31], a[56:59], v[164:167]
    s_nop 5
    s_nop 0
    v_cvt_pk_bf16_f32 v64, v152, v156
    v_mfma_f32_16x16x32_bf16 v[168:171], v[32:35], a[56:59], v[168:171]
    v_cvt_pk_bf16_f32 v68, v153, v157
    v_cvt_pk_bf16_f32 v72, v154, v158
    v_mfma_f32_16x16x32_bf16 v[172:175], v[36:39], a[56:59], v[172:175]
    v_cvt_pk_bf16_f32 v76, v155, v159
    v_cvt_pk_bf16_f32 v65, v160, v164
    v_mfma_f32_16x16x32_bf16 v[176:179], v[40:43], a[56:59], v[176:179]
    v_cvt_pk_bf16_f32 v69, v161, v165
    v_cvt_pk_bf16_f32 v73, v162, v166
    v_mfma_f32_16x16x32_bf16 v[180:183], v[44:47], a[56:59], v[180:183]
    v_cvt_pk_bf16_f32 v77, v163, v167
    s_nop 0
    s_nop 0
    v_cvt_pk_bf16_f32 v66, v168, v172
    s_waitcnt lgkmcnt(2)
    s_nop 0
    v_mfma_f32_16x16x32_bf16 v[184:187], v[16:19], a[60:63], v[184:187]
    v_cvt_pk_bf16_f32 v70, v169, v173
    v_cvt_pk_bf16_f32 v74, v170, v174
    v_mfma_f32_16x16x32_bf16 v[188:191], v[20:23], a[60:63], v[188:191]
    v_cvt_pk_bf16_f32 v78, v171, v175
    v_cvt_pk_bf16_f32 v67, v176, v180
    s_waitcnt lgkmcnt(0)
    s_nop 0
    v_mfma_f32_16x16x32_bf16 a[0:3], v[16:19], a[68:71], a[0:3]
    buffer_store_dwordx4 v[64:67], v12, s[24:27], s61 offen sc1
    v_cvt_pk_bf16_f32 v71, v177, v181
    v_mfma_f32_16x16x32_bf16 a[4:7], v[20:23], a[68:71], a[4:7]
    buffer_store_dwordx4 v[68:71], v12, s[24:27], s61 offen offset:2048 sc1
    v_cvt_pk_bf16_f32 v120, v184, v188
    v_mfma_f32_16x16x32_bf16 a[8:11], v[24:27], a[68:71], a[8:11]
    v_cvt_pk_bf16_f32 v124, v185, v189
    s_nop 0
    s_nop 0
    v_accvgpr_read_b32 v112, a0
    v_mfma_f32_16x16x32_bf16 a[12:15], v[28:31], a[68:71], a[12:15]
    v_cvt_pk_bf16_f32 v75, v178, v182
    buffer_store_dwordx4 v[72:75], v13, s[24:27], s61 offen sc1
    v_mfma_f32_16x16x32_bf16 a[16:19], v[32:35], a[68:71], a[16:19]
    v_accvgpr_read_b32 v113, a4
    v_accvgpr_read_b32 v114, a8
    v_mfma_f32_16x16x32_bf16 a[20:23], v[36:39], a[68:71], a[20:23]
    v_cvt_pk_bf16_f32 v184, v112, v113
    s_nop 0
    s_nop 0
    v_accvgpr_read_b32 v115, a12
    v_mfma_f32_16x16x32_bf16 a[24:27], v[40:43], a[68:71], a[24:27]
    v_cvt_pk_bf16_f32 v185, v114, v115
    v_cvt_pk_bf16_f32 v128, v186, v190
    v_mfma_f32_16x16x32_bf16 a[28:31], v[44:47], a[68:71], a[28:31]
    v_cvt_pk_bf16_f32 v132, v187, v191
    v_accvgpr_read_b32 v112, a16
    v_mfma_f32_16x16x32_bf16 v[192:195], v[24:27], a[60:63], v[192:195]
    v_accvgpr_read_b32 v113, a20
    s_nop 0
    s_nop 0
    v_accvgpr_read_b32 v114, a24
    v_mfma_f32_16x16x32_bf16 v[196:199], v[28:31], a[60:63], v[196:199]
    v_cvt_pk_bf16_f32 v79, v179, v183
    buffer_store_dwordx4 v[76:79], v13, s[24:27], s61 offen offset:2048 sc1
    v_mfma_f32_16x16x32_bf16 v[200:203], v[32:35], a[60:63], v[200:203]
    v_accvgpr_read_b32 v115, a28
    v_cvt_pk_bf16_f32 v186, v112, v113
    v_mfma_f32_16x16x32_bf16 v[204:207], v[36:39], a[60:63], v[204:207]
    v_cvt_pk_bf16_f32 v187, v114, v115
    s_nop 0
    s_nop 0
    v_cvt_pk_bf16_f32 v121, v192, v196
    v_mfma_f32_16x16x32_bf16 v[208:211], v[40:43], a[60:63], v[208:211]
    v_accvgpr_read_b32 v112, a1
    v_accvgpr_read_b32 v113, a5
    v_mfma_f32_16x16x32_bf16 v[212:215], v[44:47], a[60:63], v[212:215]
    v_accvgpr_read_b32 v114, a9
    v_cvt_pk_bf16_f32 v122, v200, v204
    v_mfma_f32_16x16x32_bf16 v[216:219], v[16:19], a[64:67], v[216:219]
    v_accvgpr_read_b32 v115, a13
    v_cvt_pk_bf16_f32 v125, v193, v197
    v_mfma_f32_16x16x32_bf16 v[220:223], v[20:23], a[64:67], v[220:223]
    v_cvt_pk_bf16_f32 v126, v201, v205
    s_nop 0
    s_nop 0
    v_cvt_pk_bf16_f32 v123, v208, v212
    v_mfma_f32_16x16x32_bf16 v[224:227], v[24:27], a[64:67], v[224:227]
    buffer_store_dwordx4 v[120:123], v12, s[24:27], s62 offen sc1
    v_cvt_pk_bf16_f32 v127, v209, v213
    v_mfma_f32_16x16x32_bf16 v[228:231], v[28:31], a[64:67], v[228:231]
    buffer_store_dwordx4 v[124:127], v12, s[24:27], s62 offen offset:2048 sc1
    v_cvt_pk_bf16_f32 v188, v112, v113
    v_mfma_f32_16x16x32_bf16 v[232:235], v[32:35], a[64:67], v[232:235]
    v_cvt_pk_bf16_f32 v189, v114, v115
    v_cvt_pk_bf16_f32 v129, v194, v198
    v_mfma_f32_16x16x32_bf16 v[236:239], v[36:39], a[64:67], v[236:239]
    v_cvt_pk_bf16_f32 v130, v202, v206
    v_cvt_pk_bf16_f32 v131, v210, v214
    v_mfma_f32_16x16x32_bf16 v[240:243], v[40:43], a[64:67], v[240:243]
    buffer_store_dwordx4 v[128:131], v13, s[24:27], s62 offen sc1
    v_accvgpr_read_b32 v112, a17
    v_mfma_f32_16x16x32_bf16 v[244:247], v[44:47], a[64:67], v[244:247]
    v_accvgpr_read_b32 v113, a21
    v_accvgpr_read_b32 v114, a25
    v_accvgpr_read_b32 v115, a29
    v_cvt_pk_bf16_f32 v133, v195, v199
    v_cvt_pk_bf16_f32 v134, v203, v207
    v_cvt_pk_bf16_f32 v135, v211, v215
    buffer_store_dwordx4 v[132:135], v13, s[24:27], s62 offen offset:2048 sc1
    v_cvt_pk_bf16_f32 v190, v112, v113
    v_cvt_pk_bf16_f32 v191, v114, v115
    v_cvt_pk_bf16_f32 v152, v216, v220
    v_cvt_pk_bf16_f32 v153, v224, v228
    v_cvt_pk_bf16_f32 v154, v232, v236
    v_cvt_pk_bf16_f32 v155, v240, v244
    buffer_store_dwordx4 v[152:155], v12, s[24:27], s45 offen sc1
    v_accvgpr_read_b32 v112, a2
    v_accvgpr_read_b32 v113, a6
    v_accvgpr_read_b32 v114, a10
    v_accvgpr_read_b32 v115, a14
    v_cvt_pk_bf16_f32 v156, v217, v221
    v_cvt_pk_bf16_f32 v157, v225, v229
    v_cvt_pk_bf16_f32 v158, v233, v237
    v_cvt_pk_bf16_f32 v159, v241, v245
    buffer_store_dwordx4 v[156:159], v12, s[24:27], s45 offen offset:2048 sc1
    v_cvt_pk_bf16_f32 v192, v112, v113
    v_cvt_pk_bf16_f32 v193, v114, v115
    v_cvt_pk_bf16_f32 v160, v218, v222
    v_cvt_pk_bf16_f32 v161, v226, v230
    v_cvt_pk_bf16_f32 v162, v234, v238
    v_cvt_pk_bf16_f32 v163, v242, v246
    buffer_store_dwordx4 v[160:163], v13, s[24:27], s45 offen sc1
    v_accvgpr_read_b32 v112, a18
    v_accvgpr_read_b32 v113, a22
    v_accvgpr_read_b32 v114, a26
    v_accvgpr_read_b32 v115, a30
    v_cvt_pk_bf16_f32 v164, v219, v223
    v_cvt_pk_bf16_f32 v165, v227, v231
    v_cvt_pk_bf16_f32 v166, v235, v239
    v_cvt_pk_bf16_f32 v167, v243, v247
    buffer_store_dwordx4 v[164:167], v13, s[24:27], s45 offen offset:2048 sc1
    buffer_store_dwordx4 v[184:187], v12, s[24:27], s44 offen sc1
    buffer_store_dwordx4 v[188:191], v12, s[24:27], s44 offen offset:2048 sc1
    v_cvt_pk_bf16_f32 v194, v112, v113
    v_cvt_pk_bf16_f32 v195, v114, v115
    buffer_store_dwordx4 v[192:195], v13, s[24:27], s44 offen sc1
    v_accvgpr_read_b32 v112, a3
    v_accvgpr_read_b32 v113, a7
    v_accvgpr_read_b32 v114, a11
    v_accvgpr_read_b32 v115, a15
    v_cvt_pk_bf16_f32 v196, v112, v113
    v_cvt_pk_bf16_f32 v197, v114, v115
    v_accvgpr_read_b32 v112, a19
    v_accvgpr_read_b32 v113, a23
    v_accvgpr_read_b32 v114, a27
    v_accvgpr_read_b32 v115, a31
    v_cvt_pk_bf16_f32 v198, v112, v113
    v_cvt_pk_bf16_f32 v199, v114, v115
    buffer_store_dwordx4 v[196:199], v13, s[24:27], s44 offen offset:2048 sc1
    s_mov_b32 s58, 0
L_flagchk:
    s_nop 0
    v_accvgpr_read_b32 v2, a233
    s_nop 0
    v_readfirstlane_b32 s49, v2
    s_nop 3
    s_cmp_eq_u32 s49, 0
    s_cbranch_scc1 L_flagslow
L_flagok:
    s_nop 0
    s_mov_b32 s57, 0xffff0000
    v_lshlrev_b32 v10, 7, v255
    v_lshrrev_b32 v7, 1, v254
    v_lshl_add_u32 v10, v7, 4, v10
    v_and_b32_e64 v7, 1, v254
    v_lshl_add_u32 v10, v7, 15, v10
    s_mul_i32 s59, s37, 163840
    s_lshl_b32 s47, s36, 10
    s_add_u32 s59, s59, s47
    s_lshl_b32 s47, s39, 8
    s_add_u32 s59, s59, s47
    s_lshl_b32 s47, s38, 5
    s_add_u32 s59, s59, s47
    v_and_b32 v6, 7, v0
    v_lshlrev_b32 v6, 2, v6
    s_lshl_b32 s47, s38, 2
    s_add_u32 s101, s100, s47
    v_lshlrev_b32_e64 v14, 4, v0
    v_add_u32 v15, 1024, v14
    v_mov_b32 v7, 0x40000000
    v_lshlrev_b32 v248, 0, v254
    v_add_u32 v248, 0, v248
    s_mov_b32 s58, 0
    s_mov_b64 exec, 1
    s_waitcnt vmcnt(0)
    buffer_store_dword a232, v5, s[24:27], s101 offen sc1
    s_mov_b64 exec, -1
    v_cmp_eq_u32 vcc, s38, v248
    s_nop 1
    v_cndmask_b32 v14, v14, v7, vcc
    v_lshlrev_b32_e64 v248, 0, v254
    v_add_u32 v248, 4, v248
    v_cmp_eq_u32 vcc, s38, v248
    s_nop 1
    v_cndmask_b32 v15, v15, v7, vcc
    v_cmp_eq_u32 s[90:91], v12, v7
    v_cmp_eq_u32 s[92:93], v13, v7
    v_and_b32 v248, 1, v0
    v_lshlrev_b32 v248, 4, v248
    v_mov_b32 v249, 0x3f80
    v_lshlrev_b32_e64 v248, v248, v249
    v_bfe_u32 v249, v0, 1, 3
    v_cndmask_b32 v251, 0, v248, s[90:91]
    v_cndmask_b32 v252, 0, v248, s[92:93]
    v_cmp_eq_u32 vcc, 0, v249
    s_nop 1
    v_cndmask_b32 v250, 0, v248, vcc
    s_nop 0
    v_accvgpr_write_b32 a72, v250
    v_cndmask_b32 v250, 0, v251, vcc
    s_nop 0
    v_accvgpr_write_b32 a80, v250
    v_cndmask_b32 v250, 0, v252, vcc
    s_nop 0
    v_accvgpr_write_b32 a88, v250
    v_cmp_eq_u32 vcc, 1, v249
    s_nop 1
    v_cndmask_b32 v250, 0, v248, vcc
    s_nop 0
    v_accvgpr_write_b32 a73, v250
    v_cndmask_b32 v250, 0, v251, vcc
    s_nop 0
    v_accvgpr_write_b32 a81, v250
    v_cndmask_b32 v250, 0, v252, vcc
    s_nop 0
    v_accvgpr_write_b32 a89, v250
    v_cmp_eq_u32 vcc, 2, v249
    s_nop 1
    v_cndmask_b32 v250, 0, v248, vcc
    s_nop 0
    v_accvgpr_write_b32 a74, v250
    v_cndmask_b32 v250, 0, v251, vcc
    s_nop 0
    v_accvgpr_write_b32 a82, v250
    v_cndmask_b32 v250, 0, v252, vcc
    s_nop 0
    v_accvgpr_write_b32 a90, v250
    v_cmp_eq_u32 vcc, 3, v249
    s_nop 1
    v_cndmask_b32 v250, 0, v248, vcc
    s_nop 0
    v_accvgpr_write_b32 a75, v250
    v_cndmask_b32 v250, 0, v251, vcc
    s_nop 0
    v_accvgpr_write_b32 a83, v250
    v_cndmask_b32 v250, 0, v252, vcc
    s_nop 0
    v_accvgpr_write_b32 a91, v250
    v_cmp_eq_u32 vcc, 4, v249
    s_nop 1
    v_cndmask_b32 v250, 0, v248, vcc
    s_nop 0
    v_accvgpr_write_b32 a76, v250
    v_cndmask_b32 v250, 0, v251, vcc
    s_nop 0
    v_accvgpr_write_b32 a84, v250
    v_cndmask_b32 v250, 0, v252, vcc
    s_nop 0
    v_accvgpr_write_b32 a92, v250
    v_cmp_eq_u32 vcc, 5, v249
    s_nop 1
    v_cndmask_b32 v250, 0, v248, vcc
    s_nop 0
    v_accvgpr_write_b32 a77, v250
    v_cndmask_b32 v250, 0, v251, vcc
    s_nop 0
    v_accvgpr_write_b32 a85, v250
    v_cndmask_b32 v250, 0, v252, vcc
    s_nop 0
    v_accvgpr_write_b32 a93, v250
    v_cmp_eq_u32 vcc, 6, v249
    s_nop 1
    v_cndmask_b32 v250, 0, v248, vcc
    s_nop 0
    v_accvgpr_write_b32 a78, v250
    v_cndmask_b32 v250, 0, v251, vcc
    s_nop 0
    v_accvgpr_write_b32 a86, v250
    v_cndmask_b32 v250, 0, v252, vcc
    s_nop 0
    v_accvgpr_write_b32 a94, v250
    v_cmp_eq_u32 vcc, 7, v249
    s_nop 1
    v_cndmask_b32 v250, 0, v248, vcc
    s_nop 0
    v_accvgpr_write_b32 a79, v250
    v_cndmask_b32 v250, 0, v251, vcc
    s_nop 0
    v_accvgpr_write_b32 a87, v250
    v_cndmask_b32 v250, 0, v252, vcc
    s_nop 0
    v_accvgpr_write_b32 a95, v250
    v_mfma_f32_16x16x32_bf16 v[16:19], a[80:83], v[48:51], 0
    v_mfma_f32_16x16x32_bf16 v[20:23], a[80:83], v[64:67], 0
    v_mfma_f32_16x16x32_bf16 v[24:27], a[80:83], v[120:123], 0
    v_mfma_f32_16x16x32_bf16 v[28:31], a[80:83], v[152:155], 0
    v_mfma_f32_16x16x32_bf16 v[32:35], a[80:83], v[184:187], 0
    v_mfma_f32_16x16x32_bf16 v[16:19], a[84:87], v[52:55], v[16:19]
    v_mfma_f32_16x16x32_bf16 v[20:23], a[84:87], v[68:71], v[20:23]
    v_mfma_f32_16x16x32_bf16 v[24:27], a[84:87], v[124:127], v[24:27]
    v_mfma_f32_16x16x32_bf16 v[28:31], a[84:87], v[156:159], v[28:31]
    v_mfma_f32_16x16x32_bf16 v[32:35], a[84:87], v[188:191], v[32:35]
    v_mfma_f32_16x16x32_bf16 v[16:19], a[88:91], v[56:59], v[16:19]
    v_mfma_f32_16x16x32_bf16 v[20:23], a[88:91], v[72:75], v[20:23]
    v_mfma_f32_16x16x32_bf16 v[24:27], a[88:91], v[128:131], v[24:27]
    v_mfma_f32_16x16x32_bf16 v[28:31], a[88:91], v[160:163], v[28:31]
    v_mfma_f32_16x16x32_bf16 v[32:35], a[88:91], v[192:195], v[32:35]
    v_mfma_f32_16x16x32_bf16 v[16:19], a[92:95], v[60:63], v[16:19]
    v_mfma_f32_16x16x32_bf16 v[20:23], a[92:95], v[76:79], v[20:23]
    v_mfma_f32_16x16x32_bf16 v[24:27], a[92:95], v[132:135], v[24:27]
    v_mfma_f32_16x16x32_bf16 v[28:31], a[92:95], v[164:167], v[28:31]
    v_mfma_f32_16x16x32_bf16 v[32:35], a[92:95], v[196:199], v[32:35]
    s_add_u32 s60, s56, 0
    s_nop 0
    s_add_u32 s61, s56, 4096
    s_add_u32 s62, s56, 8192
    s_add_u32 s45, s56, 12288
    s_add_u32 s44, s56, 16384
    s_nop 7
    s_nop 3
    s_branch L_pl
L_poll:
    s_sleep 4
L_pl:
    buffer_load_dword v248, v6, s[24:27], s100 offen sc1
    s_add_u32 s58, s58, 1
    s_nop 0
    s_cmp_gt_u32 s58, 0x40000
    s_waitcnt vmcnt(0)
    s_cbranch_scc1 L_go
    v_cmp_eq_u32 vcc, 0, v248
    s_nop 4
    s_cbranch_vccnz L_poll
L_go:
    s_nop 0
    buffer_load_dwordx4 v[120:123], v14, s[24:27], s60 offen sc1
    buffer_load_dwordx4 v[124:127], v15, s[24:27], s60 offen sc1
    buffer_load_dwordx4 v[128:131], v14, s[24:27], s60 offen offset:2048 sc1
    buffer_load_dwordx4 v[132:135], v15, s[24:27], s60 offen offset:2048 sc1
    buffer_load_dwordx4 v[136:139], v14, s[24:27], s61 offen sc1
    buffer_load_dwordx4 v[140:143], v15, s[24:27], s61 offen sc1
    buffer_load_dwordx4 v[144:147], v14, s[24:27], s61 offen offset:2048 sc1
    buffer_load_dwordx4 v[148:151], v15, s[24:27], s61 offen offset:2048 sc1
    buffer_load_dwordx4 v[152:155], v14, s[24:27], s62 offen sc1
    buffer_load_dwordx4 v[156:159], v15, s[24:27], s62 offen sc1
    buffer_load_dwordx4 v[160:163], v14, s[24:27], s62 offen offset:2048 sc1
    buffer_load_dwordx4 v[164:167], v15, s[24:27], s62 offen offset:2048 sc1
    buffer_load_dwordx4 v[168:171], v14, s[24:27], s45 offen sc1
    buffer_load_dwordx4 v[172:175], v15, s[24:27], s45 offen sc1
    buffer_load_dwordx4 v[176:179], v14, s[24:27], s45 offen offset:2048 sc1
    buffer_load_dwordx4 v[180:183], v15, s[24:27], s45 offen offset:2048 sc1
    buffer_load_dwordx4 v[184:187], v14, s[24:27], s44 offen sc1
    buffer_load_dwordx4 v[188:191], v15, s[24:27], s44 offen sc1
    buffer_load_dwordx4 v[192:195], v14, s[24:27], s44 offen offset:2048 sc1
    buffer_load_dwordx4 v[196:199], v15, s[24:27], s44 offen offset:2048 sc1
    s_waitcnt vmcnt(19)
    s_nop 0
    v_mfma_f32_16x16x32_bf16 v[16:19], a[72:75], v[120:123], v[16:19]
    s_waitcnt vmcnt(18)
    s_nop 0
    v_mfma_f32_16x16x32_bf16 v[16:19], a[72:75], v[124:127], v[16:19]
    s_waitcnt vmcnt(17)
    s_nop 0
    v_mfma_f32_16x16x32_bf16 v[16:19], a[76:79], v[128:131], v[16:19]
    s_waitcnt vmcnt(16)
    s_nop 0
    v_mfma_f32_16x16x32_bf16 v[16:19], a[76:79], v[132:135], v[16:19]
    s_waitcnt vmcnt(15)
    s_nop 0
    v_mfma_f32_16x16x32_bf16 v[20:23], a[72:75], v[136:139], v[20:23]
    s_waitcnt vmcnt(14)
    s_nop 0
    v_mfma_f32_16x16x32_bf16 v[20:23], a[72:75], v[140:143], v[20:23]
    s_waitcnt vmcnt(13)
    s_nop 0
    v_mfma_f32_16x16x32_bf16 v[20:23], a[76:79], v[144:147], v[20:23]
    s_waitcnt vmcnt(12)
    s_nop 0
    v_mfma_f32_16x16x32_bf16 v[20:23], a[76:79], v[148:151], v[20:23]
    s_waitcnt vmcnt(11)
    s_nop 0
    v_mfma_f32_16x16x32_bf16 v[24:27], a[72:75], v[152:155], v[24:27]
    s_waitcnt vmcnt(10)
    s_nop 0
    v_mfma_f32_16x16x32_bf16 v[24:27], a[72:75], v[156:159], v[24:27]
    s_waitcnt vmcnt(9)
    s_nop 0
    v_mfma_f32_16x16x32_bf16 v[24:27], a[76:79], v[160:163], v[24:27]
    s_waitcnt vmcnt(8)
    s_nop 0
    v_mfma_f32_16x16x32_bf16 v[24:27], a[76:79], v[164:167], v[24:27]
    v_cvt_pk_bf16_f32 v80, v16, v17
    v_cvt_pk_bf16_f32 v81, v18, v19
    v_cvt_pk_bf16_f32 v82, v20, v21
    v_cvt_pk_bf16_f32 v83, v22, v23
    s_nop 0
    v_permlane16_swap_b32 v80, v82
    v_permlane16_swap_b32 v81, v83
    s_add_u32 s48, s59, 0
    buffer_store_dwordx4 v[80:83], v10, s[28:31], s48 offen
    s_waitcnt vmcnt(8)
    s_nop 0
    v_mfma_f32_16x16x32_bf16 v[28:31], a[72:75], v[168:171], v[28:31]
    s_waitcnt vmcnt(7)
    s_nop 0
    v_mfma_f32_16x16x32_bf16 v[28:31], a[72:75], v[172:175], v[28:31]
    s_waitcnt vmcnt(6)
    s_nop 0
    v_mfma_f32_16x16x32_bf16 v[28:31], a[76:79], v[176:179], v[28:31]
    s_waitcnt vmcnt(5)
    s_nop 0
    v_mfma_f32_16x16x32_bf16 v[28:31], a[76:79], v[180:183], v[28:31]
    s_waitcnt vmcnt(4)
    s_nop 0
    v_mfma_f32_16x16x32_bf16 v[32:35], a[72:75], v[184:187], v[32:35]
    s_waitcnt vmcnt(3)
    s_nop 0
    v_mfma_f32_16x16x32_bf16 v[32:35], a[72:75], v[188:191], v[32:35]
    s_waitcnt vmcnt(2)
    s_nop 0
    v_mfma_f32_16x16x32_bf16 v[32:35], a[76:79], v[192:195], v[32:35]
    s_waitcnt vmcnt(1)
    s_nop 0
    v_mfma_f32_16x16x32_bf16 v[32:35], a[76:79], v[196:199], v[32:35]
    v_cvt_pk_bf16_f32 v84, v24, v25
    v_cvt_pk_bf16_f32 v85, v26, v27
    v_cvt_pk_bf16_f32 v86, v28, v29
    v_cvt_pk_bf16_f32 v87, v30, v31
    s_nop 0
    v_permlane16_swap_b32 v84, v86
    v_permlane16_swap_b32 v85, v87
    s_nop 0
    s_add_u32 s48, s59, 65536
    buffer_store_dwordx4 v[84:87], v10, s[28:31], s48 offen
    v_cvt_pk_bf16_f32 v88, v32, v33
    v_cvt_pk_bf16_f32 v89, v34, v35
    v_cvt_pk_bf16_f32 v90, v32, v33
    v_cvt_pk_bf16_f32 v91, v34, v35
    s_nop 0
    v_permlane16_swap_b32 v88, v90
    v_permlane16_swap_b32 v89, v91
    s_nop 0
    s_add_u32 s48, s59, 131072
    s_mov_b32 exec_lo, 0xffff
    s_mov_b32 exec_hi, 0xffff
    buffer_store_dwordx4 v[88:91], v10, s[28:31], s48 offen
    s_mov_b64 exec, -1
L_end:
    s_endpgm
L_flagslow:
    s_sleep 4
    s_nop 0
    buffer_load_dword a233, v5, s[32:35], s3 offen sc1
    s_waitcnt vmcnt(0)
    s_add_u32 s58, s58, 1
    s_cmp_lt_u32 s58, 0x40000
    s_cbranch_scc1 L_flagchk
    s_branch L_flagok
L_oK0:
    s_add_u32 s50, s45, 0
    s_add_u32 m0, s53, 0
    s_nop 0
    s_nop 0
    buffer_load_dwordx4 v248, s[8:11], s50 offen nt lds
    buffer_load_dwordx4 v249, s[8:11], s50 offen offset:1024 nt lds
    buffer_load_dwordx4 v250, s[8:11], s50 offen offset:2048 nt lds
    buffer_load_dwordx4 v251, s[8:11], s50 offen offset:3072 nt lds
    s_add_u32 s50, s45, 4096
    s_add_u32 m0, s53, 4096
    s_nop 0
    s_nop 0
    buffer_load_dwordx4 v248, s[8:11], s50 offen nt lds
    buffer_load_dwordx4 v249, s[8:11], s50 offen offset:1024 nt lds
    buffer_load_dwordx4 v250, s[8:11], s50 offen offset:2048 nt lds
    buffer_load_dwordx4 v251, s[8:11], s50 offen offset:3072 nt lds
    s_add_u32 s50, s45, 8192
    s_add_u32 m0, s53, 8192
    s_nop 0
    s_nop 0
    buffer_load_dwordx4 v248, s[8:11], s50 offen nt lds
    buffer_load_dwordx4 v249, s[8:11], s50 offen offset:1024 nt lds
    buffer_load_dwordx4 v250, s[8:11], s50 offen offset:2048 nt lds
    buffer_load_dwordx4 v251, s[8:11], s50 offen offset:3072 nt lds
    s_add_u32 s50, s45, 12288
    s_add_u32 m0, s53, 12288
    s_nop 0
    s_nop 0
    buffer_load_dwordx4 v248, s[8:11], s50 offen nt lds
    buffer_load_dwordx4 v249, s[8:11], s50 offen offset:1024 nt lds
    buffer_load_dwordx4 v250, s[8:11], s50 offen offset:2048 nt lds
    buffer_load_dwordx4 v251, s[8:11], s50 offen offset:3072 nt lds
    s_add_u32 s50, s45, 16384
    s_add_u32 m0, s53, 16384
    s_nop 0
    s_nop 0
    buffer_load_dwordx4 v248, s[8:11], s50 offen nt lds
    buffer_load_dwordx4 v249, s[8:11], s50 offen offset:1024 nt lds
    buffer_load_dwordx4 v250, s[8:11], s50 offen offset:2048 nt lds
    buffer_load_dwordx4 v251, s[8:11], s50 offen offset:3072 nt lds
    s_mov_b32 s62, 3
    s_branch L_rK0
L_oK1:
    s_add_u32 s50, s45, 0
    s_add_u32 m0, s53, 0
    s_nop 0
    s_nop 0
    buffer_load_dwordx4 v248, s[8:11], s50 offen nt lds
    buffer_load_dwordx4 v249, s[8:11], s50 offen offset:1024 nt lds
    buffer_load_dwordx4 v250, s[8:11], s50 offen offset:2048 nt lds
    buffer_load_dwordx4 v251, s[8:11], s50 offen offset:3072 nt lds
    s_add_u32 s50, s45, 4096
    s_add_u32 m0, s53, 4096
    s_nop 0
    s_nop 0
    buffer_load_dwordx4 v248, s[8:11], s50 offen nt lds
    buffer_load_dwordx4 v249, s[8:11], s50 offen offset:1024 nt lds
    buffer_load_dwordx4 v250, s[8:11], s50 offen offset:2048 nt lds
    buffer_load_dwordx4 v251, s[8:11], s50 offen offset:3072 nt lds
    s_add_u32 s50, s45, 8192
    s_add_u32 m0, s53, 8192
    s_nop 0
    s_nop 0
    buffer_load_dwordx4 v248, s[8:11], s50 offen nt lds
    buffer_load_dwordx4 v249, s[8:11], s50 offen offset:1024 nt lds
    buffer_load_dwordx4 v250, s[8:11], s50 offen offset:2048 nt lds
    buffer_load_dwordx4 v251, s[8:11], s50 offen offset:3072 nt lds
    s_add_u32 s50, s45, 12288
    s_add_u32 m0, s53, 12288
    s_nop 0
    s_nop 0
    buffer_load_dwordx4 v248, s[8:11], s50 offen nt lds
    buffer_load_dwordx4 v249, s[8:11], s50 offen offset:1024 nt lds
    buffer_load_dwordx4 v250, s[8:11], s50 offen offset:2048 nt lds
    buffer_load_dwordx4 v251, s[8:11], s50 offen offset:3072 nt lds
    s_add_u32 s50, s45, 16384
    s_add_u32 m0, s53, 16384
    s_nop 0
    s_nop 0
    buffer_load_dwordx4 v248, s[8:11], s50 offen nt lds
    buffer_load_dwordx4 v249, s[8:11], s50 offen offset:1024 nt lds
    buffer_load_dwordx4 v250, s[8:11], s50 offen offset:2048 nt lds
    buffer_load_dwordx4 v251, s[8:11], s50 offen offset:3072 nt lds
    s_mov_b32 s62, 2
    s_branch L_rK1
L_oK2:
    s_add_u32 s50, s45, 0
    s_add_u32 m0, s53, 0
    s_nop 0
    s_nop 0
    buffer_load_dwordx4 v248, s[8:11], s50 offen nt lds
    buffer_load_dwordx4 v249, s[8:11], s50 offen offset:1024 nt lds
    buffer_load_dwordx4 v250, s[8:11], s50 offen offset:2048 nt lds
    buffer_load_dwordx4 v251, s[8:11], s50 offen offset:3072 nt lds
    s_add_u32 s50, s45, 4096
    s_add_u32 m0, s53, 4096
    s_nop 0
    s_nop 0
    buffer_load_dwordx4 v248, s[8:11], s50 offen nt lds
    buffer_load_dwordx4 v249, s[8:11], s50 offen offset:1024 nt lds
    buffer_load_dwordx4 v250, s[8:11], s50 offen offset:2048 nt lds
    buffer_load_dwordx4 v251, s[8:11], s50 offen offset:3072 nt lds
    s_add_u32 s50, s45, 8192
    s_add_u32 m0, s53, 8192
    s_nop 0
    s_nop 0
    buffer_load_dwordx4 v248, s[8:11], s50 offen nt lds
    buffer_load_dwordx4 v249, s[8:11], s50 offen offset:1024 nt lds
    buffer_load_dwordx4 v250, s[8:11], s50 offen offset:2048 nt lds
    buffer_load_dwordx4 v251, s[8:11], s50 offen offset:3072 nt lds
    s_add_u32 s50, s45, 12288
    s_add_u32 m0, s53, 12288
    s_nop 0
    s_nop 0
    buffer_load_dwordx4 v248, s[8:11], s50 offen nt lds
    buffer_load_dwordx4 v249, s[8:11], s50 offen offset:1024 nt lds
    buffer_load_dwordx4 v250, s[8:11], s50 offen offset:2048 nt lds
    buffer_load_dwordx4 v251, s[8:11], s50 offen offset:3072 nt lds
    s_add_u32 s50, s45, 16384
    s_add_u32 m0, s53, 16384
    s_nop 0
    s_nop 0
    buffer_load_dwordx4 v248, s[8:11], s50 offen nt lds
    buffer_load_dwordx4 v249, s[8:11], s50 offen offset:1024 nt lds
    buffer_load_dwordx4 v250, s[8:11], s50 offen offset:2048 nt lds
    buffer_load_dwordx4 v251, s[8:11], s50 offen offset:3072 nt lds
    s_mov_b32 s62, 2
    s_branch L_rK2
L_oK3:
    s_add_u32 s50, s45, 0
    s_add_u32 m0, s53, 0
    s_nop 0
    s_nop 0
    buffer_load_dwordx4 v248, s[8:11], s50 offen nt lds
    buffer_load_dwordx4 v249, s[8:11], s50 offen offset:1024 nt lds
    buffer_load_dwordx4 v250, s[8:11], s50 offen offset:2048 nt lds
    buffer_load_dwordx4 v251, s[8:11], s50 offen offset:3072 nt lds
    s_add_u32 s50, s45, 4096
    s_add_u32 m0, s53, 4096
    s_nop 0
    s_nop 0
    buffer_load_dwordx4 v248, s[8:11], s50 offen nt lds
    buffer_load_dwordx4 v249, s[8:11], s50 offen offset:1024 nt lds
    buffer_load_dwordx4 v250, s[8:11], s50 offen offset:2048 nt lds
    buffer_load_dwordx4 v251, s[8:11], s50 offen offset:3072 nt lds
    s_add_u32 s50, s45, 8192
    s_add_u32 m0, s53, 8192
    s_nop 0
    s_nop 0
    buffer_load_dwordx4 v248, s[8:11], s50 offen nt lds
    buffer_load_dwordx4 v249, s[8:11], s50 offen offset:1024 nt lds
    buffer_load_dwordx4 v250, s[8:11], s50 offen offset:2048 nt lds
    buffer_load_dwordx4 v251, s[8:11], s50 offen offset:3072 nt lds
    s_add_u32 s50, s45, 12288
    s_add_u32 m0, s53, 12288
    s_nop 0
    s_nop 0
    buffer_load_dwordx4 v248, s[8:11], s50 offen nt lds
    buffer_load_dwordx4 v249, s[8:11], s50 offen offset:1024 nt lds
    buffer_load_dwordx4 v250, s[8:11], s50 offen offset:2048 nt lds
    buffer_load_dwordx4 v251, s[8:11], s50 offen offset:3072 nt lds
    s_add_u32 s50, s45, 16384
    s_add_u32 m0, s53, 16384
    s_nop 0
    s_nop 0
    buffer_load_dwordx4 v248, s[8:11], s50 offen nt lds
    buffer_load_dwordx4 v249, s[8:11], s50 offen offset:1024 nt lds
    buffer_load_dwordx4 v250, s[8:11], s50 offen offset:2048 nt lds
    buffer_load_dwordx4 v251, s[8:11], s50 offen offset:3072 nt lds
    s_mov_b32 s62, 2
    s_branch L_rK3
L_oK4:
    s_add_u32 s50, s45, 0
    s_add_u32 m0, s53, 0
    s_nop 0
    s_nop 0
    buffer_load_dwordx4 v248, s[8:11], s50 offen nt lds
    buffer_load_dwordx4 v249, s[8:11], s50 offen offset:1024 nt lds
    buffer_load_dwordx4 v250, s[8:11], s50 offen offset:2048 nt lds
    buffer_load_dwordx4 v251, s[8:11], s50 offen offset:3072 nt lds
    s_add_u32 s50, s45, 4096
    s_add_u32 m0, s53, 4096
    s_nop 0
    s_nop 0
    buffer_load_dwordx4 v248, s[8:11], s50 offen nt lds
    buffer_load_dwordx4 v249, s[8:11], s50 offen offset:1024 nt lds
    buffer_load_dwordx4 v250, s[8:11], s50 offen offset:2048 nt lds
    buffer_load_dwordx4 v251, s[8:11], s50 offen offset:3072 nt lds
    s_add_u32 s50, s45, 8192
    s_add_u32 m0, s53, 8192
    s_nop 0
    s_nop 0
    buffer_load_dwordx4 v248, s[8:11], s50 offen nt lds
    buffer_load_dwordx4 v249, s[8:11], s50 offen offset:1024 nt lds
    buffer_load_dwordx4 v250, s[8:11], s50 offen offset:2048 nt lds
    buffer_load_dwordx4 v251, s[8:11], s50 offen offset:3072 nt lds
    s_add_u32 s50, s45, 12288
    s_add_u32 m0, s53, 12288
    s_nop 0
    s_nop 0
    buffer_load_dwordx4 v248, s[8:11], s50 offen nt lds
    buffer_load_dwordx4 v249, s[8:11], s50 offen offset:1024 nt lds
    buffer_load_dwordx4 v250, s[8:11], s50 offen offset:2048 nt lds
    buffer_load_dwordx4 v251, s[8:11], s50 offen offset:3072 nt lds
    s_add_u32 s50, s45, 16384
    s_add_u32 m0, s53, 16384
    s_nop 0
    s_nop 0
    buffer_load_dwordx4 v248, s[8:11], s50 offen nt lds
    buffer_load_dwordx4 v249, s[8:11], s50 offen offset:1024 nt lds
    buffer_load_dwordx4 v250, s[8:11], s50 offen offset:2048 nt lds
    buffer_load_dwordx4 v251, s[8:11], s50 offen offset:3072 nt lds
    s_mov_b32 s62, 2
    s_branch L_rK4
L_oK5:
    s_add_u32 s50, s45, 0
    s_add_u32 m0, s53, 0
    s_nop 0
    s_nop 0
    buffer_load_dwordx4 v248, s[8:11], s50 offen nt lds
    buffer_load_dwordx4 v249, s[8:11], s50 offen offset:1024 nt lds
    buffer_load_dwordx4 v250, s[8:11], s50 offen offset:2048 nt lds
    buffer_load_dwordx4 v251, s[8:11], s50 offen offset:3072 nt lds
    s_add_u32 s50, s45, 4096
    s_add_u32 m0, s53, 4096
    s_nop 0
    s_nop 0
    buffer_load_dwordx4 v248, s[8:11], s50 offen nt lds
    buffer_load_dwordx4 v249, s[8:11], s50 offen offset:1024 nt lds
    buffer_load_dwordx4 v250, s[8:11], s50 offen offset:2048 nt lds
    buffer_load_dwordx4 v251, s[8:11], s50 offen offset:3072 nt lds
    s_add_u32 s50, s45, 8192
    s_add_u32 m0, s53, 8192
    s_nop 0
    s_nop 0
    buffer_load_dwordx4 v248, s[8:11], s50 offen nt lds
    buffer_load_dwordx4 v249, s[8:11], s50 offen offset:1024 nt lds
    buffer_load_dwordx4 v250, s[8:11], s50 offen offset:2048 nt lds
    buffer_load_dwordx4 v251, s[8:11], s50 offen offset:3072 nt lds
    s_add_u32 s50, s45, 12288
    s_add_u32 m0, s53, 12288
    s_nop 0
    s_nop 0
    buffer_load_dwordx4 v248, s[8:11], s50 offen nt lds
    buffer_load_dwordx4 v249, s[8:11], s50 offen offset:1024 nt lds
    buffer_load_dwordx4 v250, s[8:11], s50 offen offset:2048 nt lds
    buffer_load_dwordx4 v251, s[8:11], s50 offen offset:3072 nt lds
    s_add_u32 s50, s45, 16384
    s_add_u32 m0, s53, 16384
    s_nop 0
    s_nop 0
    buffer_load_dwordx4 v248, s[8:11], s50 offen nt lds
    buffer_load_dwordx4 v249, s[8:11], s50 offen offset:1024 nt lds
    buffer_load_dwordx4 v250, s[8:11], s50 offen offset:2048 nt lds
    buffer_load_dwordx4 v251, s[8:11], s50 offen offset:3072 nt lds
    s_mov_b32 s62, 2
    s_branch L_rK5
L_oK6:
    s_add_u32 s50, s45, 0
    s_add_u32 m0, s53, 0
    s_nop 0
    s_nop 0
    buffer_load_dwordx4 v248, s[8:11], s50 offen nt lds
    buffer_load_dwordx4 v249, s[8:11], s50 offen offset:1024 nt lds
    buffer_load_dwordx4 v250, s[8:11], s50 offen offset:2048 nt lds
    buffer_load_dwordx4 v251, s[8:11], s50 offen offset:3072 nt lds
    s_add_u32 s50, s45, 4096
    s_add_u32 m0, s53, 4096
    s_nop 0
    s_nop 0
    buffer_load_dwordx4 v248, s[8:11], s50 offen nt lds
    buffer_load_dwordx4 v249, s[8:11], s50 offen offset:1024 nt lds
    buffer_load_dwordx4 v250, s[8:11], s50 offen offset:2048 nt lds
    buffer_load_dwordx4 v251, s[8:11], s50 offen offset:3072 nt lds
    s_add_u32 s50, s45, 8192
    s_add_u32 m0, s53, 8192
    s_nop 0
    s_nop 0
    buffer_load_dwordx4 v248, s[8:11], s50 offen nt lds
    buffer_load_dwordx4 v249, s[8:11], s50 offen offset:1024 nt lds
    buffer_load_dwordx4 v250, s[8:11], s50 offen offset:2048 nt lds
    buffer_load_dwordx4 v251, s[8:11], s50 offen offset:3072 nt lds
    s_add_u32 s50, s45, 12288
    s_add_u32 m0, s53, 12288
    s_nop 0
    s_nop 0
    buffer_load_dwordx4 v248, s[8:11], s50 offen nt lds
    buffer_load_dwordx4 v249, s[8:11], s50 offen offset:1024 nt lds
    buffer_load_dwordx4 v250, s[8:11], s50 offen offset:2048 nt lds
    buffer_load_dwordx4 v251, s[8:11], s50 offen offset:3072 nt lds
    s_add_u32 s50, s45, 16384
    s_add_u32 m0, s53, 16384
    s_nop 0
    s_nop 0
    buffer_load_dwordx4 v248, s[8:11], s50 offen nt lds
    buffer_load_dwordx4 v249, s[8:11], s50 offen offset:1024 nt lds
    buffer_load_dwordx4 v250, s[8:11], s50 offen offset:2048 nt lds
    buffer_load_dwordx4 v251, s[8:11], s50 offen offset:3072 nt lds
    s_mov_b32 s62, 2
    s_branch L_rK6
L_oK7:
    s_add_u32 s50, s45, 0
    s_add_u32 m0, s53, 0
    s_nop 0
    s_nop 0
    buffer_load_dwordx4 v248, s[8:11], s50 offen nt lds
    buffer_load_dwordx4 v249, s[8:11], s50 offen offset:1024 nt lds
    buffer_load_dwordx4 v250, s[8:11], s50 offen offset:2048 nt lds
    buffer_load_dwordx4 v251, s[8:11], s50 offen offset:3072 nt lds
    s_add_u32 s50, s45, 4096
    s_add_u32 m0, s53, 4096
    s_nop 0
    s_nop 0
    buffer_load_dwordx4 v248, s[8:11], s50 offen nt lds
    buffer_load_dwordx4 v249, s[8:11], s50 offen offset:1024 nt lds
    buffer_load_dwordx4 v250, s[8:11], s50 offen offset:2048 nt lds
    buffer_load_dwordx4 v251, s[8:11], s50 offen offset:3072 nt lds
    s_add_u32 s50, s45, 8192
    s_add_u32 m0, s53, 8192
    s_nop 0
    s_nop 0
    buffer_load_dwordx4 v248, s[8:11], s50 offen nt lds
    buffer_load_dwordx4 v249, s[8:11], s50 offen offset:1024 nt lds
    buffer_load_dwordx4 v250, s[8:11], s50 offen offset:2048 nt lds
    buffer_load_dwordx4 v251, s[8:11], s50 offen offset:3072 nt lds
    s_add_u32 s50, s45, 12288
    s_add_u32 m0, s53, 12288
    s_nop 0
    s_nop 0
    buffer_load_dwordx4 v248, s[8:11], s50 offen nt lds
    buffer_load_dwordx4 v249, s[8:11], s50 offen offset:1024 nt lds
    buffer_load_dwordx4 v250, s[8:11], s50 offen offset:2048 nt lds
    buffer_load_dwordx4 v251, s[8:11], s50 offen offset:3072 nt lds
    s_add_u32 s50, s45, 16384
    s_add_u32 m0, s53, 16384
    s_nop 0
    s_nop 0
    buffer_load_dwordx4 v248, s[8:11], s50 offen nt lds
    buffer_load_dwordx4 v249, s[8:11], s50 offen offset:1024 nt lds
    buffer_load_dwordx4 v250, s[8:11], s50 offen offset:2048 nt lds
    buffer_load_dwordx4 v251, s[8:11], s50 offen offset:3072 nt lds
    s_mov_b32 s62, 2
    s_branch L_rK7

.fill 2976, 4, 0xBF800000
.section .rodata,"a"
.p2align 6
.amdhsa_kernel concat_heads__gqa_block_cached__gqa_block_cached__near_ridge_kernel
  .amdhsa_next_free_vgpr 496
  .amdhsa_next_free_sgpr 102
  .amdhsa_accum_offset 256
  .amdhsa_group_segment_fixed_size 0
  .amdhsa_kernarg_size 104
  .amdhsa_user_sgpr_count 2
  .amdhsa_user_sgpr_kernarg_segment_ptr 1
  .amdhsa_system_sgpr_workgroup_id_x 1
.end_amdhsa_kernel
```
